```python
import torch

def _softmax(x, axis=-1):
    return torch.softmax(x, dim=axis)
def _gelu(x):
    return torch.nn.functional.gelu(x, approximate="tanh")
def _silu(x):
    return torch.nn.functional.silu(x)
def _sigmoid(x):
    return torch.sigmoid(x)
def _layernorm(x, axis=-1, eps=1e-5):
    m = x.mean(dim=axis, keepdim=True)
    v = x.var(dim=axis, keepdim=True, unbiased=False)
    return (x - m) / torch.sqrt(v + eps)
def _scatter_add(tgt, idx, src, axis=0):
    return tgt.clone().index_add_(axis, idx, src)
def _segment_sum(src, seg, n):
    out = torch.zeros((n,) + src.shape[1:], dtype=src.dtype)
    return out.index_add_(0, seg, src)
def _pad(x, pw):
    flat = tuple(v for pair in reversed(pw) for v in pair)
    return torch.nn.functional.pad(x, flat)

kernel_name = 'sequential_preLN__sliding_block_cached__moe_arch_mod__decode'

def setup_inputs():

    _w = (lambda a: (lambda t: t.to(torch.bfloat16) if t.is_floating_point() else t)(torch.as_tensor(a)))
    def _A_setup():
        B, Sq, D = 8, 1, 640
        Hq, Hkv, Sk, Dh = 32, 32, 4096, 128
        assert Hq % Hkv == 0, (Hq, Hkv)
        return {
            "x": _w((lambda *s: torch.randn(*s, dtype=torch.bfloat16) * 0.1)(B, Sq, D)),
            "k_cache": _w((lambda *s: torch.randn(*s, dtype=torch.bfloat16) * 0.8)(B, Hkv, Sk, Dh)),
            "v_cache": _w((lambda *s: torch.randn(*s, dtype=torch.bfloat16) * 1.6)(B, Hkv, Sk, Dh)),
            "wq": _w((lambda *s: torch.randn(*s, dtype=torch.bfloat16) * 0.8)(D, Hq * Dh) * (D ** -0.5)),
            "wo": _w((lambda *s: torch.randn(*s, dtype=torch.bfloat16) * 1.6)(Hq * Dh, D) * ((Hq * Dh) ** -0.5)),
        }
    _A_in = _A_setup()

    def _B_setup():
        B, S, D, F, C = 8, 1, 640, 1728, 1
        return {
            "x": _w((lambda *s: torch.randn(*s, dtype=torch.bfloat16) * 0.1)(B, S, D)),
            "w_r": _w((lambda *s: torch.randn(*s, dtype=torch.bfloat16) * 3.2)(D)),
            "w_gate": _w((lambda *s: torch.randn(*s, dtype=torch.bfloat16) * 0.2)(D, F)),
            "w_up": _w((lambda *s: torch.randn(*s, dtype=torch.bfloat16) * 0.2)(D, F)),
            "w_down": _w((lambda *s: torch.randn(*s, dtype=torch.bfloat16) * 0.2)(F, D)),
        }
    _B_in = _B_setup()

    return {
        "A_x": _A_in["x"],
        "A_k_cache": _A_in["k_cache"],
        "A_v_cache": _A_in["v_cache"],
        "A_wq": _A_in["wq"],
        "A_wo": _A_in["wo"],
        "B_x": _B_in["x"],
        "B_w_r": _B_in["w_r"],
        "B_w_gate": _B_in["w_gate"],
        "B_w_up": _B_in["w_up"],
        "B_w_down": _B_in["w_down"],
    }

def reference(A_x, A_k_cache, A_v_cache, A_wq, A_wo, B_x, B_w_r, B_w_gate, B_w_up, B_w_down):
    def _A_ref(x, k_cache, v_cache, wq, wo):
        B, Sq, D = x.shape
        Hq, Dh = 32, 128
        Hkv, Sk = k_cache.shape[1], k_cache.shape[2]
        W = min(4096, max(256, Sk // 4))
        rep = Hq // Hkv
        q = (lambda x, *d: x.permute(*d))((x @ wq).reshape(B, Sq, Hq, Dh), 0, 2, 1, 3)
        k = (lambda x, n, axis: torch.repeat_interleave(x, n, dim=axis))(k_cache[:, :, Sk - W:, :], rep, axis=1)
        v = (lambda x, n, axis: torch.repeat_interleave(x, n, dim=axis))(v_cache[:, :, Sk - W:, :], rep, axis=1)
        scores = torch.einsum("bhqd,bhkd->bhqk", q, k) * (Dh ** -0.5)
        p = _softmax(scores, axis=-1)
        o = torch.einsum("bhqk,bhkd->bhqd", p, v)
        return (lambda x, *d: x.permute(*d))(o, 0, 2, 1, 3).reshape(B, Sq, Hq * Dh) @ wo

    def _B_ref(x, w_r, w_gate, w_up, w_down):
        B, S, D = x.shape
        C = 1
        r = x @ w_r
        idx = torch.argsort(-r, axis=-1)[:, :C]
        idx_e = (lambda x, n, axis: torch.repeat_interleave(x, n, dim=axis))(idx.reshape(B, C, 1), D, axis=2)
        x_sel = (lambda x, i, axis: torch.take_along_dim(x, i, dim=axis))(x, idx_e, axis=1)
        g = _silu(x_sel @ w_gate)
        u = x_sel @ w_up
        y = (g * u) @ w_down
        r_sel = _sigmoid((lambda x, i, axis: torch.take_along_dim(x, i, dim=axis))(r, idx, axis=1))
        y = y * r_sel.reshape(B, C, 1)
        b_off = (torch.arange(B) * S).reshape(B, 1)
        flat_idx = (idx + b_off).reshape(B * C)
        zero = (x * 0.0).reshape(B * S, D)
        upd = _scatter_add(zero, flat_idx, y.reshape(B * C, D), axis=0)
        return x + upd.reshape(B, S, D)

    x = A_x
    h = x + _A_ref(_layernorm(x, axis=-1), A_k_cache, A_v_cache, A_wq, A_wo)
    h2 = h + _B_ref(_layernorm(h, axis=-1), B_w_r, B_w_gate, B_w_up, B_w_down)
    return h2
```

```asm
; @launch grid=(256,1,1) block=(512,1,1) lds=81984
.amdgcn_target "amdgcn-amd-amdhsa--gfx950"
.text
.globl sequential_preLN__sliding_block_cached__moe_arch_mod__decode_kernel
.p2align 8
.type sequential_preLN__sliding_block_cached__moe_arch_mod__decode_kernel,@function
sequential_preLN__sliding_block_cached__moe_arch_mod__decode_kernel:
    s_load_dwordx16 s[4:19], s[0:1], 0
    s_cmp_ge_u32 s2, 256
    s_cbranch_scc1 L_end
    s_load_dwordx8 s[20:27], s[0:1], 64
    s_load_dwordx2 s[28:29], s[0:1], 96
    s_and_b32 s31, s2, 7
    s_lshr_b32 s3, s2, 3
    s_and_b32 s68, s3, 7
    s_lshr_b32 s64, s2, 6
    s_mul_i32 s69, s64, 2
    s_add_u32 s69, s69, s31
    s_and_b32 s69, s69, 7
    s_lshl3_add_u32 s69, s64, s69
    s_lshl_b32 s64, s68, 5
    s_add_u32 s64, s64, s69
    s_lshl_b32 s65, s64, 20
    s_add_u32 s65, s65, 786432
    v_lshlrev_b32 v1, 4, v0
    v_lshrrev_b32 v22, 6, v0
    v_and_b32 v122, 63, v0
    v_readfirstlane_b32 s30, v22
    s_mov_b32 s34, 262144
    s_mov_b32 s35, 0x20000
    s_waitcnt lgkmcnt(0)
    s_add_u32 s32, s6, s65
    s_addc_u32 s33, s7, 0
    buffer_load_dwordx4 v[128:131], v1, s[32:35], 0 offen nt
    s_mov_b32 s64, 8192
    buffer_load_dwordx4 v[132:135], v1, s[32:35], s64 offen nt
    s_add_u32 s36, s8, s65
    s_addc_u32 s37, s9, 0
    s_mov_b32 s38, 262144
    s_mov_b32 s39, 0x20000
    s_mul_i32 s65, s68, 1280
    s_add_u32 s48, s4, s65
    s_addc_u32 s49, s5, 0
    s_mov_b32 s50, 1280
    s_mov_b32 s51, 0x20000
    s_mov_b32 s40, s10
    s_mov_b32 s41, s11
    s_mov_b32 s42, 5242880
    s_mov_b32 s43, 0x20000
    s_mov_b32 s44, s12
    s_mov_b32 s45, s13
    s_mov_b32 s46, 5242880
    s_mov_b32 s47, 0x20000
    v_lshrrev_b32 v123, 4, v122
    v_and_b32 v124, 15, v0
    v_lshrrev_b32 v22, 4, v0
    v_lshlrev_b32 v24, 4, v122
    v_lshlrev_b32 v25, 2, v122
    v_lshl_add_u32 v26, v124, 5, v22
    v_lshlrev_b32 v26, 1, v26
    v_mov_b32 v125, v26
    s_cmp_eq_u32 s30, 0
    s_cbranch_scc0 L_nox
    buffer_load_dwordx4 v[96:99], v24, s[48:51], 0 offen
    buffer_load_dword v100, v25, s[48:51], 0 offen offset:1024
L_nox:
    v_lshlrev_b32 v23, 4, v124
    v_lshl_add_u32 v2, v22, 13, v23
    s_lshl_b32 s65, s69, 8
    v_add_u32 v2, s65, v2
    s_lshl3_add_u32 s64, s68, s30
    s_mul_i32 s64, s64, 81920
    s_lshl_b32 s65, s69, 8
    s_add_u32 s64, s64, s65
    v_lshrrev_b32 v57, 1, v122
    v_and_b32 v58, 1, v122
    v_lshlrev_b32 v58, 7, v58
    v_lshl_add_u32 v57, v57, 13, v58
    s_mov_b64 exec, 0xfffff
    buffer_load_dword v56, v57, s[40:43], s64 offen
    s_mov_b64 exec, -1
    s_lshl3_add_u32 s64, s69, s68
    s_lshl3_add_u32 s64, s64, s30
    s_mul_i32 s64, s64, 2560
    v_lshlrev_b32 v57, 7, v122
    s_mov_b64 exec, 0xfffff
    buffer_load_dword v56, v57, s[44:47], s64 offen
    s_mov_b64 exec, -1
    s_load_dword s0, s[28:29], 0xc00
    s_mov_b32 s1, 1
    s_mov_b32 s52, s28
    s_mov_b32 s53, s29
    s_mov_b32 s54, 1441792
    s_mov_b32 s55, 0x20000
    s_mul_i32 s64, s2, 2850
    s_lshr_b32 s64, s64, 16
    s_mul_i32 s64, s64, 23
    s_sub_u32 s64, s2, s64
    s_add_u32 s14, s64, 3
    s_mul_i32 s64, s2, 2622
    s_lshr_b32 s64, s64, 16
    s_mul_i32 s64, s64, 25
    s_sub_u32 s64, s2, s64
    s_add_u32 s15, s64, 32
    v_lshrrev_b32 v3, 3, v122
    v_mul_u32_u24 v3, 1280, v3
    v_and_b32 v27, 7, v122
    v_lshl_add_u32 v3, v27, 4, v3
    s_mul_i32 s65, s69, 1280
    s_add_u32 s65, s65, s30
    s_lshl_b32 s65, s65, 7
    v_add_u32 v3, s65, v3
    v_mov_b32 v126, 0
    v_and_b32 v27, 1, v124
    v_lshlrev_b32 v27, 4, v27
    v_mov_b32 v28, 0xffff
    v_lshlrev_b32 v27, v27, v28
    v_lshrrev_b32 v28, 1, v124
    v_cmp_eq_u32 vcc, 0, v28
    v_mov_b32 v12, 0
    v_mov_b32 v104, -1
    v_cndmask_b32 v4, 0, v27, vcc
    v_cmp_eq_u32 vcc, 1, v28
    v_mov_b32 v13, 0
    v_mov_b32 v105, -1
    v_cndmask_b32 v5, 0, v27, vcc
    v_cmp_eq_u32 vcc, 2, v28
    v_mov_b32 v14, 0
    v_mov_b32 v106, -1
    v_cndmask_b32 v6, 0, v27, vcc
    v_cmp_eq_u32 vcc, 3, v28
    v_mov_b32 v15, 0
    v_mov_b32 v107, -1
    v_cndmask_b32 v7, 0, v27, vcc
    s_mul_i32 s65, s30, 544
    v_lshl_add_u32 v116, v122, 4, s65
    v_lshl_add_u32 v116, v123, 4, v116
    v_mov_b32 v28, 2147483648
    v_mov_b32 v61, 2147483648
    v_and_b32 v29, 7, v122
    v_lshrrev_b32 v30, 3, v122
    s_mov_b32 s66, 0
    s_mov_b32 s67, 0
    s_cmp_lt_u32 s31, 3
    s_cselect_b32 s65, 16, 12
    s_cmp_lt_u32 s3, s65
    s_cbranch_scc0 L_r_n1
    s_mov_b32 s66, 1
    s_min_u32 s64, s31, 3
    s_mul_i32 s65, s31, 3
    s_add_u32 s64, s64, s65
    s_lshl2_add_u32 s67, s64, s3
    s_cmp_lt_u32 s30, 2
    s_cbranch_scc0 L_r_done
    s_lshl1_add_u32 s64, s67, s30
    s_and_b32 s65, s64, 0xc0
    s_add_u32 s64, s64, s65
    s_lshl_b32 s64, s64, 7
    s_add_u32 s64, s64, 1179648
    v_and_b32 v31, 1, v30
    v_lshl_add_u32 v27, v31, 4, s64
    v_and_b32 v31, 1, v123
    v_lshl_add_u32 v27, v31, 6, v27
    v_lshrrev_b32 v31, 1, v123
    v_lshl_add_u32 v27, v31, 5, v27
    v_cmp_eq_u32 vcc, 0, v29
    s_mov_b32 s65, 0x2000
    s_nop 0
    v_cndmask_b32 v61, v28, v27, vcc
    buffer_store_dwordx4 v[104:107], v61, s[52:55], 0 offen sc1
    buffer_store_dwordx4 v[104:107], v61, s[52:55], s65 offen sc1
    s_branch L_r_done
L_r_n1:
    s_cmp_lt_u32 s3, 28
    s_cbranch_scc0 L_r_ge28
    s_cmp_lt_u32 s3, 16
    s_cbranch_scc1 L_r_done
    s_cmp_lt_u32 s3, 24
    s_cbranch_scc0 L_r_ge24
    s_mov_b32 s66, 2
    s_lshl3_add_u32 s64, s31, s3
    s_sub_u32 s67, s64, 16
    s_branch L_r_done
L_r_ge24:
    s_cmp_ge_u32 s31, 4
    s_cbranch_scc0 L_r_done
    s_mov_b32 s66, 2
    s_lshl2_add_u32 s64, s31, s3
    s_add_u32 s67, s64, 24
    s_branch L_r_done
L_r_ge28:
    s_mov_b32 s66, 3
    s_sub_u32 s64, s3, 28
    s_mul_i32 s64, s64, 5
    s_sub_u32 s65, s30, 2
    s_add_u32 s67, s64, s65
    s_cmp_lt_u32 s65, 5
    s_cselect_b32 s67, s67, 20
    s_cbranch_scc0 L_r_done
    s_and_b32 s64, s31, 3
    s_mul_i32 s64, s64, 1280
    s_lshr_b32 s65, s31, 2
    s_lshl_b32 s65, s65, 14
    s_add_u32 s64, s64, s65
    s_lshl_b32 s65, s67, 6
    s_add_u32 s64, s64, s65
    s_add_u32 s64, s64, 1048576
    v_lshl_add_u32 v27, v29, 3, s64
    v_and_b32 v31, 3, v30
    v_lshl_add_u32 v27, v31, 15, v27
    v_lshrrev_b32 v31, 2, v30
    v_lshl_add_u32 v27, v31, 13, v27
    v_and_b32 v31, 1, v122
    v_cmp_eq_u32 vcc, 0, v31
    s_nop 1
    v_cndmask_b32 v61, v28, v27, vcc
L_r_done:
    s_getreg_b32 s8, hwreg(HW_REG_XCC_ID)
    s_bfe_u32 s8, s8, 0x10002
    s_cmp_lt_u32 s31, 4
    s_cselect_b32 s64, 6, 3
    s_lshr_b32 s65, s3, 2
    s_cmp_eq_u32 s64, s65
    s_cselect_b32 s9, 24, 0
    s_add_u32 s9, s9, s30
    s_and_b32 s64, s2, 31
    s_sub_u32 s65, s9, 24
    s_cmp_lt_u32 s65, 3
    s_cbranch_scc0 L_nohc
    s_lshr_b32 s65, s64, 1
    s_lshl_b32 s65, s65, 13
    s_bitcmp1_b32 s64, 0
    s_cselect_b32 s56, 2560, 0
    s_add_u32 s65, s65, s56
    s_add_u32 s65, s65, 1048576
    v_cmp_gt_u32 vcc, 2560, v1
    s_nop 1
    v_cndmask_b32 v27, v28, v1, vcc
    buffer_store_dwordx4 v[104:107], v27, s[52:55], s65 offen sc1
L_nohc:
    s_lshl_b32 s64, s64, 14
    s_add_u32 s56, s28, s64
    s_addc_u32 s57, s29, 0
    s_cmp_eq_u32 s9, 31
    s_cbranch_scc0 L_nowarm
    s_load_dword s10, s[56:57], 0xe00
    s_load_dword s11, s[56:57], 0x2e00
    s_cmp_lt_u32 s64, 65536
    s_cselect_b32 s64, s8, 0
    s_add_u32 s65, s31, 24
    s_lshl_b32 s64, s64, s65
    s_add_u32 s1, s1, s64
L_nowarm:
    s_waitcnt vmcnt(3)
    s_mov_b32 s64, 16384
    buffer_load_dwordx4 v[136:139], v1, s[32:35], s64 offen nt
    s_cmp_eq_u32 s30, 6
    s_cbranch_scc0 L_nopw
    s_and_b32 s64, s68, 3
    s_lshl_b32 s64, s64, 4
    s_lshr_b32 s65, s69, 1
    s_add_u32 s64, s64, s65
    s_lshr_b32 s65, s68, 2
    s_lshl1_add_u32 s64, s64, s65
    s_and_b32 s65, s69, 1
    s_lshl1_add_u32 s64, s64, s65
    s_lshl_b32 s64, s64, 12
    v_lshlrev_b32 v57, 7, v122
    s_mov_b64 exec, 0xfffff
    buffer_load_dword v56, v57, s[52:55], s64 offen
    s_mov_b64 exec, -1
L_nopw:
    s_waitcnt vmcnt(3)
    s_mov_b32 s64, 24576
    buffer_load_dwordx4 v[140:143], v1, s[32:35], s64 offen nt
    s_waitcnt vmcnt(3)
    s_mov_b32 s64, 32768
    buffer_load_dwordx4 v[144:147], v1, s[32:35], s64 offen nt
    s_cmp_eq_u32 s30, 0
    s_cbranch_scc0 L_noln1
    v_mov_b32 v28, 0x3f803f80
    v_mov_b32 v29, 0x3acccccd
    v_dot2_f32_bf16 v27, v96, v96, 0
    v_dot2_f32_bf16 v26, v96, v28, 0
    v_dot2_f32_bf16 v27, v97, v97, v27
    v_dot2_f32_bf16 v26, v97, v28, v26
    v_dot2_f32_bf16 v27, v98, v98, v27
    v_dot2_f32_bf16 v26, v98, v28, v26
    v_dot2_f32_bf16 v27, v99, v99, v27
    v_dot2_f32_bf16 v26, v99, v28, v26
    v_dot2_f32_bf16 v27, v100, v100, v27
    v_dot2_f32_bf16 v26, v100, v28, v26
    v_lshlrev_b32 v40, 16, v96
    v_and_b32 v41, 0xffff0000, v96
    v_lshlrev_b32 v42, 16, v97
    v_add_f32_dpp v27, v27, v27 row_ror:8 row_mask:0xf bank_mask:0xf
    v_add_f32_dpp v26, v26, v26 row_ror:8 row_mask:0xf bank_mask:0xf
    v_and_b32 v43, 0xffff0000, v97
    v_add_f32_dpp v27, v27, v27 row_ror:4 row_mask:0xf bank_mask:0xf
    v_add_f32_dpp v26, v26, v26 row_ror:4 row_mask:0xf bank_mask:0xf
    v_lshlrev_b32 v44, 16, v98
    v_add_f32_dpp v27, v27, v27 row_ror:2 row_mask:0xf bank_mask:0xf
    v_add_f32_dpp v26, v26, v26 row_ror:2 row_mask:0xf bank_mask:0xf
    v_and_b32 v45, 0xffff0000, v98
    v_add_f32_dpp v27, v27, v27 row_ror:1 row_mask:0xf bank_mask:0xf
    v_add_f32_dpp v26, v26, v26 row_ror:1 row_mask:0xf bank_mask:0xf
    v_lshlrev_b32 v46, 16, v99
    v_add_f32_dpp v27, v27, v27 row_bcast:15 row_mask:0xa bank_mask:0xf
    v_add_f32_dpp v26, v26, v26 row_bcast:15 row_mask:0xa bank_mask:0xf
    v_and_b32 v47, 0xffff0000, v99
    v_add_f32_dpp v27, v27, v27 row_bcast:31 row_mask:0xc bank_mask:0xf
    v_add_f32_dpp v26, v26, v26 row_bcast:31 row_mask:0xc bank_mask:0xf
    v_lshlrev_b32 v48, 16, v100
    v_readlane_b32 s65, v27, 63
    v_readlane_b32 s64, v26, 63
    v_and_b32 v49, 0xffff0000, v100
    v_mul_f32 v32, s65, v29
    v_mul_f32 v30, s64, v29
    v_fma_f32 v32, -v30, v30, v32
    v_cvt_pk_bf16_f32 v30, 0, v30
    v_max_f32 v32, 0, v32
    v_cvt_pk_bf16_f32 v32, 0, v32
    v_pk_add_f32 v[40:41], v[40:41], v[30:31] op_sel_hi:[1,0] neg_lo:[0,1] neg_hi:[0,1]
    v_pk_add_f32 v[42:43], v[42:43], v[30:31] op_sel_hi:[1,0] neg_lo:[0,1] neg_hi:[0,1]
    v_add_f32 v32, 0x3727c5ac, v32
    v_pk_add_f32 v[44:45], v[44:45], v[30:31] op_sel_hi:[1,0] neg_lo:[0,1] neg_hi:[0,1]
    v_pk_add_f32 v[46:47], v[46:47], v[30:31] op_sel_hi:[1,0] neg_lo:[0,1] neg_hi:[0,1]
    v_cvt_pk_bf16_f32 v32, 0, v32
    v_pk_add_f32 v[48:49], v[48:49], v[30:31] op_sel_hi:[1,0] neg_lo:[0,1] neg_hi:[0,1]
    v_cvt_pk_bf16_f32 v40, 0, v40
    v_sqrt_f32 v32, v32
    v_cvt_pk_bf16_f32 v41, 0, v41
    v_cvt_pk_bf16_f32 v42, 0, v42
    v_cvt_pk_bf16_f32 v32, 0, v32
    v_cvt_pk_bf16_f32 v43, 0, v43
    v_cvt_pk_bf16_f32 v44, 0, v44
    v_rcp_f32 v32, v32
    v_cvt_pk_bf16_f32 v45, 0, v45
    v_cvt_pk_bf16_f32 v46, 0, v46
    v_cvt_pk_bf16_f32 v47, 0, v47
    v_cvt_pk_bf16_f32 v48, 0, v48
    v_cvt_pk_bf16_f32 v49, 0, v49
    v_pk_mul_f32 v[40:41], v[40:41], v[32:33] op_sel_hi:[1,0]
    v_pk_mul_f32 v[42:43], v[42:43], v[32:33] op_sel_hi:[1,0]
    v_pk_mul_f32 v[44:45], v[44:45], v[32:33] op_sel_hi:[1,0]
    v_pk_mul_f32 v[46:47], v[46:47], v[32:33] op_sel_hi:[1,0]
    v_pk_mul_f32 v[48:49], v[48:49], v[32:33] op_sel_hi:[1,0]
    v_cvt_pk_bf16_f32 v50, v40, v41
    v_cvt_pk_bf16_f32 v51, v42, v43
    v_cvt_pk_bf16_f32 v52, v44, v45
    v_cvt_pk_bf16_f32 v53, v46, v47
    v_cvt_pk_bf16_f32 v54, v48, v49
    ds_write_b128 v24, v[50:53] offset:8192
    ds_write_b32 v25, v54 offset:9216
L_noln1:
    s_waitcnt vmcnt(3)
    s_mov_b32 s64, 40960
    buffer_load_dwordx4 v[148:151], v1, s[32:35], s64 offen nt
    s_waitcnt vmcnt(3)
    s_mov_b32 s64, 49152
    buffer_load_dwordx4 v[152:155], v1, s[32:35], s64 offen nt
    s_waitcnt vmcnt(3)
    s_cmp_eq_u32 s14, 3
    s_cbranch_scc0 L_nq3
    s_call_b64 s[6:7], L_bq
L_nq3:
    s_mov_b32 s64, 57344
    buffer_load_dwordx4 v[156:159], v1, s[32:35], s64 offen nt
    s_waitcnt vmcnt(3)
    s_cmp_eq_u32 s14, 4
    s_cbranch_scc0 L_nq4
    s_call_b64 s[6:7], L_bq
L_nq4:
    s_mov_b32 s64, 65536
    buffer_load_dwordx4 v[160:163], v1, s[32:35], s64 offen nt
    s_waitcnt vmcnt(3)
    s_cmp_eq_u32 s14, 5
    s_cbranch_scc0 L_nq5
    s_call_b64 s[6:7], L_bq
L_nq5:
    s_mov_b32 s64, 73728
    buffer_load_dwordx4 v[164:167], v1, s[32:35], s64 offen nt
    s_waitcnt vmcnt(3)
    s_cmp_eq_u32 s14, 6
    s_cbranch_scc0 L_nq6
    s_call_b64 s[6:7], L_bq
L_nq6:
    s_mov_b32 s64, 81920
    buffer_load_dwordx4 v[168:171], v1, s[32:35], s64 offen nt
    s_cmp_eq_u32 s30, 5
    s_cbranch_scc0 L_nocpf
    s_getpc_b64 s[60:61]
    s_and_b32 s64, s3, 31
    s_lshl_b32 s64, s64, 9
    v_lshl_add_u32 v22, v122, 7, s64
    v_min_u32 v22, L_code_end - L_nocpf - 4, v22
    s_mov_b64 exec, 0xff
    global_load_dword v23, v22, s[60:61]
    s_mov_b64 exec, -1
L_nocpf:
    s_waitcnt vmcnt(3)
    s_cmp_eq_u32 s14, 7
    s_cbranch_scc0 L_nq7
    s_call_b64 s[6:7], L_bq
L_nq7:
    s_mov_b32 s64, 90112
    buffer_load_dwordx4 v[172:175], v1, s[32:35], s64 offen nt
    s_waitcnt vmcnt(3)
    s_cmp_eq_u32 s14, 8
    s_cbranch_scc0 L_nq8
    s_call_b64 s[6:7], L_bq
L_nq8:
    s_mov_b32 s64, 98304
    buffer_load_dwordx4 v[176:179], v1, s[32:35], s64 offen nt
    s_waitcnt vmcnt(3)
    s_cmp_eq_u32 s14, 9
    s_cbranch_scc0 L_nq9
    s_call_b64 s[6:7], L_bq
L_nq9:
    s_mov_b32 s64, 106496
    buffer_load_dwordx4 v[180:183], v1, s[32:35], s64 offen nt
    s_cmp_eq_u32 s9, 31
    s_cbranch_scc0 L_norace0
    s_waitcnt lgkmcnt(0)
    s_not_b64 s[12:13], s[10:11]
    s_load_dword s12, s[56:57], 0xe00 glc
    s_load_dword s13, s[56:57], 0x2e00 glc
    s_waitcnt lgkmcnt(1)
    s_xor_b64 s[64:65], s[12:13], s[10:11]
    s_sub_u32 s64, s65, s64
    s_add_u32 s64, s64, 1
    s_sub_u32 s65, 2, s64
    s_cmp_eq_u32 s8, 0
    s_cselect_b32 s64, s64, s65
    s_lshl_b32 s64, s64, 8
    s_add_u32 s1, s1, s64
L_norace0:
    s_waitcnt vmcnt(3)
    s_cmp_eq_u32 s14, 10
    s_cbranch_scc0 L_nq10
    s_call_b64 s[6:7], L_bq
L_nq10:
    s_mov_b32 s64, 114688
    buffer_load_dwordx4 v[184:187], v1, s[32:35], s64 offen nt
    s_waitcnt vmcnt(3)
    s_cmp_eq_u32 s14, 11
    s_cbranch_scc0 L_nq11
    s_call_b64 s[6:7], L_bq
L_nq11:
    s_mov_b32 s64, 122880
    buffer_load_dwordx4 v[188:191], v1, s[32:35], s64 offen nt
    s_waitcnt vmcnt(3)
    s_cmp_eq_u32 s14, 12
    s_cbranch_scc0 L_nq12
    s_call_b64 s[6:7], L_bq
L_nq12:
    s_mov_b32 s64, 131072
    buffer_load_dwordx4 v[192:195], v1, s[32:35], s64 offen nt
    s_waitcnt vmcnt(3)
    s_cmp_eq_u32 s14, 13
    s_cbranch_scc0 L_nq13
    s_call_b64 s[6:7], L_bq
L_nq13:
    s_mov_b32 s64, 139264
    buffer_load_dwordx4 v[196:199], v1, s[32:35], s64 offen nt
    s_cmp_eq_u32 s9, 31
    s_cbranch_scc0 L_norace1
    s_waitcnt lgkmcnt(0)
    s_not_b64 s[12:13], s[10:11]
    s_load_dword s13, s[56:57], 0x2e00 glc
    s_load_dword s12, s[56:57], 0xe00 glc
    s_waitcnt lgkmcnt(1)
    s_xor_b64 s[64:65], s[12:13], s[10:11]
    s_sub_u32 s64, s65, s64
    s_add_u32 s64, s64, 1
    s_sub_u32 s65, 2, s64
    s_cmp_eq_u32 s8, 0
    s_cselect_b32 s64, s64, s65
    s_lshl_b32 s64, s64, 8
    s_add_u32 s1, s1, s64
L_norace1:
    s_waitcnt vmcnt(3)
    s_cmp_eq_u32 s14, 14
    s_cbranch_scc0 L_nq14
    s_call_b64 s[6:7], L_bq
L_nq14:
    s_mov_b32 s64, 147456
    buffer_load_dwordx4 v[200:203], v1, s[32:35], s64 offen nt
    s_waitcnt vmcnt(3)
    s_cmp_eq_u32 s14, 15
    s_cbranch_scc0 L_nq15
    s_call_b64 s[6:7], L_bq
L_nq15:
    s_mov_b32 s64, 155648
    buffer_load_dwordx4 v[204:207], v1, s[32:35], s64 offen nt
    s_waitcnt vmcnt(3)
    s_cmp_eq_u32 s14, 16
    s_cbranch_scc0 L_nq16
    s_call_b64 s[6:7], L_bq
L_nq16:
    s_mov_b32 s64, 163840
    buffer_load_dwordx4 v[208:211], v1, s[32:35], s64 offen nt
    s_waitcnt vmcnt(3)
    s_cmp_eq_u32 s14, 17
    s_cbranch_scc0 L_nq17
    s_call_b64 s[6:7], L_bq
L_nq17:
    s_mov_b32 s64, 172032
    buffer_load_dwordx4 v[212:215], v1, s[32:35], s64 offen nt
    s_waitcnt vmcnt(3)
    s_cmp_eq_u32 s14, 18
    s_cbranch_scc0 L_nq18
    s_call_b64 s[6:7], L_bq
L_nq18:
    s_mov_b32 s64, 180224
    buffer_load_dwordx4 v[216:219], v1, s[32:35], s64 offen nt
    s_waitcnt vmcnt(3)
    s_cmp_eq_u32 s14, 19
    s_cbranch_scc0 L_nq19
    s_call_b64 s[6:7], L_bq
L_nq19:
    s_mov_b32 s64, 188416
    buffer_load_dwordx4 v[220:223], v1, s[32:35], s64 offen nt
    s_waitcnt vmcnt(3)
    s_cmp_eq_u32 s14, 20
    s_cbranch_scc0 L_nq20
    s_call_b64 s[6:7], L_bq
L_nq20:
    s_mov_b32 s64, 196608
    buffer_load_dwordx4 v[224:227], v1, s[32:35], s64 offen nt
    s_waitcnt vmcnt(3)
    s_cmp_eq_u32 s14, 21
    s_cbranch_scc0 L_nq21
    s_call_b64 s[6:7], L_bq
L_nq21:
    s_mov_b32 s64, 204800
    buffer_load_dwordx4 v[228:231], v1, s[32:35], s64 offen nt
    s_waitcnt vmcnt(3)
    s_cmp_eq_u32 s14, 22
    s_cbranch_scc0 L_nq22
    s_call_b64 s[6:7], L_bq
L_nq22:
    s_mov_b32 s64, 212992
    buffer_load_dwordx4 v[232:235], v1, s[32:35], s64 offen nt
    s_waitcnt vmcnt(3)
    s_cmp_eq_u32 s14, 23
    s_cbranch_scc0 L_nq23
    s_call_b64 s[6:7], L_bq
L_nq23:
    s_mov_b32 s64, 221184
    buffer_load_dwordx4 v[236:239], v1, s[32:35], s64 offen nt
    s_waitcnt vmcnt(3)
    s_cmp_eq_u32 s14, 24
    s_cbranch_scc0 L_nq24
    s_call_b64 s[6:7], L_bq
L_nq24:
    s_mov_b32 s64, 229376
    buffer_load_dwordx4 v[240:243], v1, s[32:35], s64 offen nt
    s_waitcnt vmcnt(3)
    s_cmp_eq_u32 s14, 25
    s_cbranch_scc0 L_nq25
    s_call_b64 s[6:7], L_bq
L_nq25:
    s_mov_b32 s64, 237568
    buffer_load_dwordx4 v[244:247], v1, s[32:35], s64 offen nt
    s_mov_b32 s64, 245760
    buffer_load_dwordx4 v[248:251], v1, s[32:35], s64 offen nt
    s_nop 7
    s_mov_b32 exec_hi, 0
    ds_write_b128 v116, v[12:15] offset:0
    s_mov_b32 exec_hi, -1
    s_waitcnt lgkmcnt(0)
    s_barrier
    v_lshlrev_b32 v22, 4, v124
    ds_read_b128 v[40:43], v22 offset:0
    ds_read_b128 v[96:99], v22 offset:272
    ds_read_b128 v[44:47], v22 offset:544
    ds_read_b128 v[100:103], v22 offset:816
    ds_read_b128 v[48:51], v22 offset:1088
    ds_read_b128 v[104:107], v22 offset:1360
    ds_read_b128 v[52:55], v22 offset:1632
    ds_read_b128 v[108:111], v22 offset:1904
    s_waitcnt lgkmcnt(0)
    v_pk_add_f32 v[26:27], v[40:41], v[44:45]
    v_pk_add_f32 v[26:27], v[26:27], v[48:49]
    v_pk_add_f32 v[26:27], v[26:27], v[52:53]
    v_pk_add_f32 v[28:29], v[42:43], v[46:47]
    v_pk_add_f32 v[28:29], v[28:29], v[50:51]
    v_pk_add_f32 v[28:29], v[28:29], v[54:55]
    v_pk_add_f32 v[30:31], v[96:97], v[100:101]
    v_pk_add_f32 v[30:31], v[30:31], v[104:105]
    v_pk_add_f32 v[30:31], v[30:31], v[108:109]
    v_pk_add_f32 v[32:33], v[98:99], v[102:103]
    v_pk_add_f32 v[32:33], v[32:33], v[106:107]
    v_pk_add_f32 v[32:33], v[32:33], v[110:111]
    ds_read_b128 v[40:43], v22 offset:2176
    ds_read_b128 v[96:99], v22 offset:2448
    ds_read_b128 v[44:47], v22 offset:2720
    ds_read_b128 v[100:103], v22 offset:2992
    ds_read_b128 v[48:51], v22 offset:3264
    ds_read_b128 v[104:107], v22 offset:3536
    ds_read_b128 v[52:55], v22 offset:3808
    ds_read_b128 v[108:111], v22 offset:4080
    s_waitcnt lgkmcnt(0)
    v_pk_add_f32 v[26:27], v[26:27], v[40:41]
    v_pk_add_f32 v[26:27], v[26:27], v[44:45]
    v_pk_add_f32 v[26:27], v[26:27], v[48:49]
    v_pk_add_f32 v[26:27], v[26:27], v[52:53]
    v_pk_add_f32 v[28:29], v[28:29], v[42:43]
    v_pk_add_f32 v[28:29], v[28:29], v[46:47]
    v_pk_add_f32 v[28:29], v[28:29], v[50:51]
    v_pk_add_f32 v[28:29], v[28:29], v[54:55]
    v_pk_add_f32 v[30:31], v[30:31], v[96:97]
    v_pk_add_f32 v[30:31], v[30:31], v[100:101]
    v_pk_add_f32 v[30:31], v[30:31], v[104:105]
    v_pk_add_f32 v[30:31], v[30:31], v[108:109]
    v_pk_add_f32 v[32:33], v[32:33], v[98:99]
    v_pk_add_f32 v[32:33], v[32:33], v[102:103]
    v_pk_add_f32 v[32:33], v[32:33], v[106:107]
    v_pk_add_f32 v[32:33], v[32:33], v[110:111]
    v_cvt_pk_bf16_f32 v16, v26, v27
    v_cvt_pk_bf16_f32 v17, v28, v29
    v_cvt_pk_bf16_f32 v18, v30, v31
    v_cvt_pk_bf16_f32 v19, v32, v33
    v_mov_b32 v12, 0
    v_mov_b32 v13, 0
    v_mov_b32 v14, 0
    v_mov_b32 v15, 0
    s_mov_b32 s10, 0xcccccccc
    s_mov_b32 s11, 0xcccccccc
    s_mov_b32 s12, 0xaaaaaaaa
    s_mov_b32 s13, 0xaaaaaaaa
    v_dot2_f32_bf16 v40, v128, v16, 0
    v_dot2_f32_bf16 v40, v129, v17, v40
    v_dot2_f32_bf16 v40, v130, v18, v40
    v_dot2_f32_bf16 v40, v131, v19, v40
    v_dot2_f32_bf16 v41, v132, v16, 0
    v_dot2_f32_bf16 v41, v133, v17, v41
    v_dot2_f32_bf16 v41, v134, v18, v41
    v_dot2_f32_bf16 v41, v135, v19, v41
    v_dot2_f32_bf16 v42, v136, v16, 0
    v_dot2_f32_bf16 v42, v137, v17, v42
    v_dot2_f32_bf16 v42, v138, v18, v42
    v_dot2_f32_bf16 v42, v139, v19, v42
    v_dot2_f32_bf16 v43, v140, v16, 0
    v_dot2_f32_bf16 v43, v141, v17, v43
    v_dot2_f32_bf16 v43, v142, v18, v43
    v_dot2_f32_bf16 v43, v143, v19, v43
    v_dot2_f32_bf16 v44, v144, v16, 0
    v_dot2_f32_bf16 v44, v145, v17, v44
    v_dot2_f32_bf16 v44, v146, v18, v44
    v_dot2_f32_bf16 v44, v147, v19, v44
    v_dot2_f32_bf16 v45, v148, v16, 0
    v_dot2_f32_bf16 v45, v149, v17, v45
    v_dot2_f32_bf16 v45, v150, v18, v45
    v_dot2_f32_bf16 v45, v151, v19, v45
    s_waitcnt vmcnt(4)
    v_dot2_f32_bf16 v46, v152, v16, 0
    v_dot2_f32_bf16 v46, v153, v17, v46
    v_dot2_f32_bf16 v46, v154, v18, v46
    v_dot2_f32_bf16 v46, v155, v19, v46
    v_dot2_f32_bf16 v47, v156, v16, 0
    v_dot2_f32_bf16 v47, v157, v17, v47
    v_dot2_f32_bf16 v47, v158, v18, v47
    v_dot2_f32_bf16 v47, v159, v19, v47
    v_dot2_f32_bf16 v48, v160, v16, 0
    v_dot2_f32_bf16 v48, v161, v17, v48
    v_dot2_f32_bf16 v48, v162, v18, v48
    v_dot2_f32_bf16 v48, v163, v19, v48
    v_dot2_f32_bf16 v49, v164, v16, 0
    v_dot2_f32_bf16 v49, v165, v17, v49
    v_dot2_f32_bf16 v49, v166, v18, v49
    v_dot2_f32_bf16 v49, v167, v19, v49
    v_dot2_f32_bf16 v50, v168, v16, 0
    v_dot2_f32_bf16 v50, v169, v17, v50
    v_dot2_f32_bf16 v50, v170, v18, v50
    v_dot2_f32_bf16 v50, v171, v19, v50
    v_dot2_f32_bf16 v51, v172, v16, 0
    v_dot2_f32_bf16 v51, v173, v17, v51
    v_dot2_f32_bf16 v51, v174, v18, v51
    v_dot2_f32_bf16 v51, v175, v19, v51
    s_waitcnt vmcnt(3)
    s_mov_b32 s64, 253952
    buffer_load_dwordx4 v[252:255], v1, s[32:35], s64 offen nt
    v_dot2_f32_bf16 v52, v176, v16, 0
    v_dot2_f32_bf16 v52, v177, v17, v52
    v_dot2_f32_bf16 v52, v178, v18, v52
    v_dot2_f32_bf16 v52, v179, v19, v52
    v_dot2_f32_bf16 v53, v180, v16, 0
    v_dot2_f32_bf16 v53, v181, v17, v53
    v_dot2_f32_bf16 v53, v182, v18, v53
    v_dot2_f32_bf16 v53, v183, v19, v53
    v_dot2_f32_bf16 v54, v184, v16, 0
    v_dot2_f32_bf16 v54, v185, v17, v54
    v_dot2_f32_bf16 v54, v186, v18, v54
    v_dot2_f32_bf16 v54, v187, v19, v54
    v_dot2_f32_bf16 v55, v188, v16, 0
    v_dot2_f32_bf16 v55, v189, v17, v55
    v_dot2_f32_bf16 v55, v190, v18, v55
    v_dot2_f32_bf16 v55, v191, v19, v55
    v_add_f32_dpp v40, v40, v40 row_ror:8 row_mask:0xf bank_mask:0x3
    v_add_f32_dpp v41, v41, v41 row_ror:8 row_mask:0xf bank_mask:0x3
    v_add_f32_dpp v42, v42, v42 row_ror:8 row_mask:0xf bank_mask:0x3
    v_add_f32_dpp v43, v43, v43 row_ror:8 row_mask:0xf bank_mask:0x3
    v_add_f32_dpp v44, v44, v44 row_ror:8 row_mask:0xf bank_mask:0x3
    v_add_f32_dpp v45, v45, v45 row_ror:8 row_mask:0xf bank_mask:0x3
    v_add_f32_dpp v46, v46, v46 row_ror:8 row_mask:0xf bank_mask:0x3
    v_add_f32_dpp v47, v47, v47 row_ror:8 row_mask:0xf bank_mask:0x3
    v_add_f32_dpp v40, v48, v48 row_ror:8 row_mask:0xf bank_mask:0xc
    v_add_f32_dpp v41, v49, v49 row_ror:8 row_mask:0xf bank_mask:0xc
    v_add_f32_dpp v42, v50, v50 row_ror:8 row_mask:0xf bank_mask:0xc
    v_add_f32_dpp v43, v51, v51 row_ror:8 row_mask:0xf bank_mask:0xc
    v_add_f32_dpp v44, v52, v52 row_ror:8 row_mask:0xf bank_mask:0xc
    v_add_f32_dpp v45, v53, v53 row_ror:8 row_mask:0xf bank_mask:0xc
    v_add_f32_dpp v46, v54, v54 row_ror:8 row_mask:0xf bank_mask:0xc
    v_add_f32_dpp v47, v55, v55 row_ror:8 row_mask:0xf bank_mask:0xc
    v_add_f32_dpp v40, v40, v40 row_shl:4 row_mask:0xf bank_mask:0x5
    v_add_f32_dpp v41, v41, v41 row_shl:4 row_mask:0xf bank_mask:0x5
    v_add_f32_dpp v42, v42, v42 row_shl:4 row_mask:0xf bank_mask:0x5
    v_add_f32_dpp v43, v43, v43 row_shl:4 row_mask:0xf bank_mask:0x5
    v_add_f32_dpp v40, v44, v44 row_shr:4 row_mask:0xf bank_mask:0xa
    v_add_f32_dpp v41, v45, v45 row_shr:4 row_mask:0xf bank_mask:0xa
    v_add_f32_dpp v42, v46, v46 row_shr:4 row_mask:0xf bank_mask:0xa
    v_add_f32_dpp v43, v47, v47 row_shr:4 row_mask:0xf bank_mask:0xa
    v_add_f32_dpp v40, v40, v40 quad_perm:[2,3,0,1] row_mask:0xf bank_mask:0xf
    v_add_f32_dpp v41, v41, v41 quad_perm:[2,3,0,1] row_mask:0xf bank_mask:0xf
    v_add_f32_dpp v42, v42, v42 quad_perm:[2,3,0,1] row_mask:0xf bank_mask:0xf
    v_add_f32_dpp v43, v43, v43 quad_perm:[2,3,0,1] row_mask:0xf bank_mask:0xf
    v_cndmask_b32 v40, v40, v42, s[10:11]
    v_cndmask_b32 v41, v41, v43, s[10:11]
    s_nop 0
    v_add_f32_dpp v40, v40, v40 quad_perm:[1,0,3,2] row_mask:0xf bank_mask:0xf
    v_add_f32_dpp v41, v41, v41 quad_perm:[1,0,3,2] row_mask:0xf bank_mask:0xf
    v_cndmask_b32 v20, v40, v41, s[12:13]
    v_cvt_pk_bf16_f32 v20, 0, v20
    v_mul_f32 v20, 0x3db504f3, v20
    v_cvt_pk_bf16_f32 v20, 0, v20
    v_dot2_f32_bf16 v40, v192, v16, 0
    v_dot2_f32_bf16 v40, v193, v17, v40
    v_dot2_f32_bf16 v40, v194, v18, v40
    v_dot2_f32_bf16 v40, v195, v19, v40
    v_dot2_f32_bf16 v41, v196, v16, 0
    v_dot2_f32_bf16 v41, v197, v17, v41
    v_dot2_f32_bf16 v41, v198, v18, v41
    v_dot2_f32_bf16 v41, v199, v19, v41
    s_waitcnt vmcnt(3)
    buffer_load_dwordx4 v[64:67], v1, s[36:39], 0 offen nt
    v_dot2_f32_bf16 v42, v200, v16, 0
    v_dot2_f32_bf16 v42, v201, v17, v42
    v_dot2_f32_bf16 v42, v202, v18, v42
    v_dot2_f32_bf16 v42, v203, v19, v42
    v_dot2_f32_bf16 v43, v204, v16, 0
    v_dot2_f32_bf16 v43, v205, v17, v43
    v_dot2_f32_bf16 v43, v206, v18, v43
    v_dot2_f32_bf16 v43, v207, v19, v43
    v_dot2_f32_bf16 v44, v208, v16, 0
    v_dot2_f32_bf16 v44, v209, v17, v44
    v_dot2_f32_bf16 v44, v210, v18, v44
    v_dot2_f32_bf16 v44, v211, v19, v44
    v_dot2_f32_bf16 v45, v212, v16, 0
    v_dot2_f32_bf16 v45, v213, v17, v45
    v_dot2_f32_bf16 v45, v214, v18, v45
    v_dot2_f32_bf16 v45, v215, v19, v45
    v_dot2_f32_bf16 v46, v216, v16, 0
    v_dot2_f32_bf16 v46, v217, v17, v46
    v_dot2_f32_bf16 v46, v218, v18, v46
    v_dot2_f32_bf16 v46, v219, v19, v46
    v_dot2_f32_bf16 v47, v220, v16, 0
    v_dot2_f32_bf16 v47, v221, v17, v47
    v_dot2_f32_bf16 v47, v222, v18, v47
    v_dot2_f32_bf16 v47, v223, v19, v47
    s_waitcnt vmcnt(3)
    s_mov_b32 s64, 8192
    buffer_load_dwordx4 v[68:71], v1, s[36:39], s64 offen nt
    v_dot2_f32_bf16 v48, v224, v16, 0
    v_dot2_f32_bf16 v48, v225, v17, v48
    v_dot2_f32_bf16 v48, v226, v18, v48
    v_dot2_f32_bf16 v48, v227, v19, v48
    v_dot2_f32_bf16 v49, v228, v16, 0
    v_dot2_f32_bf16 v49, v229, v17, v49
    v_dot2_f32_bf16 v49, v230, v18, v49
    v_dot2_f32_bf16 v49, v231, v19, v49
    v_dot2_f32_bf16 v50, v232, v16, 0
    v_dot2_f32_bf16 v50, v233, v17, v50
    v_dot2_f32_bf16 v50, v234, v18, v50
    v_dot2_f32_bf16 v50, v235, v19, v50
    v_dot2_f32_bf16 v51, v236, v16, 0
    v_dot2_f32_bf16 v51, v237, v17, v51
    v_dot2_f32_bf16 v51, v238, v18, v51
    v_dot2_f32_bf16 v51, v239, v19, v51
    v_dot2_f32_bf16 v52, v240, v16, 0
    v_dot2_f32_bf16 v52, v241, v17, v52
    v_dot2_f32_bf16 v52, v242, v18, v52
    v_dot2_f32_bf16 v52, v243, v19, v52
    v_dot2_f32_bf16 v53, v244, v16, 0
    v_dot2_f32_bf16 v53, v245, v17, v53
    v_dot2_f32_bf16 v53, v246, v18, v53
    v_dot2_f32_bf16 v53, v247, v19, v53
    s_waitcnt vmcnt(3)
    s_mov_b32 s64, 16384
    buffer_load_dwordx4 v[72:75], v1, s[36:39], s64 offen nt
    v_dot2_f32_bf16 v54, v248, v16, 0
    v_dot2_f32_bf16 v54, v249, v17, v54
    v_dot2_f32_bf16 v54, v250, v18, v54
    v_dot2_f32_bf16 v54, v251, v19, v54
    s_waitcnt vmcnt(3)
    s_mov_b32 s64, 24576
    buffer_load_dwordx4 v[76:79], v1, s[36:39], s64 offen nt
    s_mov_b32 s64, 32768
    buffer_load_dwordx4 v[80:83], v1, s[36:39], s64 offen nt
    v_dot2_f32_bf16 v55, v252, v16, 0
    v_dot2_f32_bf16 v55, v253, v17, v55
    v_dot2_f32_bf16 v55, v254, v18, v55
    v_dot2_f32_bf16 v55, v255, v19, v55
    v_add_f32_dpp v40, v40, v40 row_ror:8 row_mask:0xf bank_mask:0x3
    v_add_f32_dpp v41, v41, v41 row_ror:8 row_mask:0xf bank_mask:0x3
    v_add_f32_dpp v42, v42, v42 row_ror:8 row_mask:0xf bank_mask:0x3
    v_add_f32_dpp v43, v43, v43 row_ror:8 row_mask:0xf bank_mask:0x3
    v_add_f32_dpp v44, v44, v44 row_ror:8 row_mask:0xf bank_mask:0x3
    v_add_f32_dpp v45, v45, v45 row_ror:8 row_mask:0xf bank_mask:0x3
    v_add_f32_dpp v46, v46, v46 row_ror:8 row_mask:0xf bank_mask:0x3
    v_add_f32_dpp v47, v47, v47 row_ror:8 row_mask:0xf bank_mask:0x3
    v_add_f32_dpp v40, v48, v48 row_ror:8 row_mask:0xf bank_mask:0xc
    v_add_f32_dpp v41, v49, v49 row_ror:8 row_mask:0xf bank_mask:0xc
    v_add_f32_dpp v42, v50, v50 row_ror:8 row_mask:0xf bank_mask:0xc
    v_add_f32_dpp v43, v51, v51 row_ror:8 row_mask:0xf bank_mask:0xc
    v_add_f32_dpp v44, v52, v52 row_ror:8 row_mask:0xf bank_mask:0xc
    v_add_f32_dpp v45, v53, v53 row_ror:8 row_mask:0xf bank_mask:0xc
    v_add_f32_dpp v46, v54, v54 row_ror:8 row_mask:0xf bank_mask:0xc
    v_add_f32_dpp v47, v55, v55 row_ror:8 row_mask:0xf bank_mask:0xc
    v_add_f32_dpp v40, v40, v40 row_shl:4 row_mask:0xf bank_mask:0x5
    v_add_f32_dpp v41, v41, v41 row_shl:4 row_mask:0xf bank_mask:0x5
    v_add_f32_dpp v42, v42, v42 row_shl:4 row_mask:0xf bank_mask:0x5
    v_add_f32_dpp v43, v43, v43 row_shl:4 row_mask:0xf bank_mask:0x5
    v_add_f32_dpp v40, v44, v44 row_shr:4 row_mask:0xf bank_mask:0xa
    v_add_f32_dpp v41, v45, v45 row_shr:4 row_mask:0xf bank_mask:0xa
    v_add_f32_dpp v42, v46, v46 row_shr:4 row_mask:0xf bank_mask:0xa
    v_add_f32_dpp v43, v47, v47 row_shr:4 row_mask:0xf bank_mask:0xa
    v_add_f32_dpp v40, v40, v40 quad_perm:[2,3,0,1] row_mask:0xf bank_mask:0xf
    v_add_f32_dpp v41, v41, v41 quad_perm:[2,3,0,1] row_mask:0xf bank_mask:0xf
    v_add_f32_dpp v42, v42, v42 quad_perm:[2,3,0,1] row_mask:0xf bank_mask:0xf
    v_add_f32_dpp v43, v43, v43 quad_perm:[2,3,0,1] row_mask:0xf bank_mask:0xf
    v_cndmask_b32 v40, v40, v42, s[10:11]
    v_cndmask_b32 v41, v41, v43, s[10:11]
    s_nop 0
    v_add_f32_dpp v40, v40, v40 quad_perm:[1,0,3,2] row_mask:0xf bank_mask:0xf
    v_add_f32_dpp v41, v41, v41 quad_perm:[1,0,3,2] row_mask:0xf bank_mask:0xf
    v_cndmask_b32 v21, v40, v41, s[12:13]
    v_cvt_pk_bf16_f32 v21, 0, v21
    v_mul_f32 v21, 0x3db504f3, v21
    v_cvt_pk_bf16_f32 v21, 0, v21
    v_max_f32 v22, v20, v21
    s_nop 1
    v_max_f32_dpp v22, v22, v22 row_ror:8 row_mask:0xf bank_mask:0xf
    s_lshl_b32 s64, s30, 3
    v_mov_b32 v24, s64
    v_max_f32_dpp v22, v22, v22 row_ror:4 row_mask:0xf bank_mask:0xf
    v_and_b32 v25, 7, v122
    v_lshlrev_b32 v25, 3, v25
    v_max_f32_dpp v22, v22, v22 row_ror:2 row_mask:0xf bank_mask:0xf
    s_nop 1
    v_max_f32_dpp v22, v22, v22 row_ror:1 row_mask:0xf bank_mask:0xf
    s_nop 1
    v_max_f32_dpp v22, v22, v22 row_bcast:15 row_mask:0xa bank_mask:0xf
    s_nop 1
    v_max_f32_dpp v22, v22, v22 row_bcast:31 row_mask:0xc bank_mask:0xf
    s_nop 0
    v_readlane_b32 s65, v22, 63
    s_nop 1
    v_subrev_f32 v26, s65, v20
    v_subrev_f32 v27, s65, v21
    s_mov_b32 s10, 0x3fb8aa3b
    v_mul_f32 v28, s10, v26
    v_mul_f32 v30, s10, v27
    v_fma_f32 v29, s10, v26, -v28
    v_fma_f32 v31, s10, v27, -v30
    v_fmac_f32 v29, 0x32a57060, v26
    v_fmac_f32 v31, 0x32a57060, v27
    v_exp_f32 v26, v28
    v_exp_f32 v27, v30
    v_mul_f32 v29, 0x3f317218, v29
    v_mul_f32 v31, 0x3f317218, v31
    v_fmac_f32 v26, v26, v29
    v_fmac_f32 v27, v27, v31
    v_add_f32 v23, v26, v27
    s_nop 1
    v_add_f32_dpp v23, v23, v23 row_ror:8 row_mask:0xf bank_mask:0xf
    s_nop 1
    v_add_f32_dpp v23, v23, v23 row_ror:4 row_mask:0xf bank_mask:0xf
    s_nop 1
    v_add_f32_dpp v23, v23, v23 row_ror:2 row_mask:0xf bank_mask:0xf
    s_nop 1
    v_add_f32_dpp v23, v23, v23 row_ror:1 row_mask:0xf bank_mask:0xf
    s_nop 1
    v_add_f32_dpp v23, v23, v23 row_bcast:15 row_mask:0xa bank_mask:0xf
    s_nop 1
    v_add_f32_dpp v23, v23, v23 row_bcast:31 row_mask:0xc bank_mask:0xf
    s_mov_b32 exec_lo, 0
    s_mov_b32 exec_hi, 0x80000000
    ds_write_b64 v24, v[22:23] offset:4352
    s_mov_b64 exec, -1
    s_waitcnt lgkmcnt(0)
    s_barrier
    ds_read_b64 v[22:23], v25 offset:4352
    s_waitcnt lgkmcnt(0)
    v_max_f32_dpp v24, v22, v22 row_ror:4 row_mask:0xf bank_mask:0xf
    s_nop 1
    v_max_f32_dpp v24, v24, v24 row_ror:2 row_mask:0xf bank_mask:0xf
    s_nop 1
    v_max_f32_dpp v24, v24, v24 row_ror:1 row_mask:0xf bank_mask:0xf
    v_sub_f32 v22, v22, v24
    v_sub_f32 v20, v20, v24
    v_sub_f32 v21, v21, v24
    s_mov_b32 s10, 0x3fb8aa3b
    v_mul_f32 v28, s10, v22
    v_mul_f32 v30, s10, v20
    v_mul_f32 v32, s10, v21
    v_fma_f32 v29, s10, v22, -v28
    v_fma_f32 v31, s10, v20, -v30
    v_fma_f32 v33, s10, v21, -v32
    v_fmac_f32 v29, 0x32a57060, v22
    v_fmac_f32 v31, 0x32a57060, v20
    v_fmac_f32 v33, 0x32a57060, v21
    v_exp_f32 v22, v28
    v_exp_f32 v20, v30
    v_exp_f32 v21, v32
    v_mul_f32 v29, 0x3f317218, v29
    v_mul_f32 v31, 0x3f317218, v31
    v_mul_f32 v33, 0x3f317218, v33
    v_fmac_f32 v22, v22, v29
    v_fmac_f32 v20, v20, v31
    v_fmac_f32 v21, v21, v33
    v_mul_f32 v22, v22, v23
    s_nop 1
    v_add_f32_dpp v22, v22, v22 row_ror:4 row_mask:0xf bank_mask:0xf
    s_nop 1
    v_add_f32_dpp v22, v22, v22 row_ror:2 row_mask:0xf bank_mask:0xf
    s_nop 1
    v_add_f32_dpp v22, v22, v22 row_ror:1 row_mask:0xf bank_mask:0xf
    v_rcp_f32 v23, v22
    s_nop 0
    v_fma_f32 v24, -v22, v23, 1.0
    v_fmac_f32 v23, v23, v24
    v_mul_f32 v20, v20, v23
    v_mul_f32 v21, v21, v23
    v_cvt_pk_bf16_f32 v20, v20, v20
    v_cvt_pk_bf16_f32 v21, v21, v21
    s_cmp_eq_u32 s9, 31
    s_cbranch_scc0 L_nosig
    s_atomic_add s1, s[26:27], 0x0
L_nosig:
    v_and_b32_dpp v8, v20, v4 row_newbcast:0 row_mask:0xf bank_mask:0xf
    v_and_b32_dpp v9, v20, v5 row_newbcast:0 row_mask:0xf bank_mask:0xf
    v_and_b32_dpp v10, v20, v6 row_newbcast:0 row_mask:0xf bank_mask:0xf
    v_and_b32_dpp v11, v20, v7 row_newbcast:0 row_mask:0xf bank_mask:0xf
    s_waitcnt vmcnt(4)
    s_nop 0
    v_mfma_f32_16x16x32_bf16 v[12:15], v[8:11], v[64:67], v[12:15]
    s_cmp_eq_u32 s15, 32
    s_cbranch_scc0 L_no32
    s_call_b64 s[6:7], L_bo
L_no32:
    v_and_b32_dpp v8, v20, v4 row_newbcast:1 row_mask:0xf bank_mask:0xf
    v_and_b32_dpp v9, v20, v5 row_newbcast:1 row_mask:0xf bank_mask:0xf
    v_and_b32_dpp v10, v20, v6 row_newbcast:1 row_mask:0xf bank_mask:0xf
    v_and_b32_dpp v11, v20, v7 row_newbcast:1 row_mask:0xf bank_mask:0xf
    s_waitcnt vmcnt(3)
    s_nop 0
    v_mfma_f32_16x16x32_bf16 v[12:15], v[8:11], v[68:71], v[12:15]
    s_cmp_eq_u32 s15, 33
    s_cbranch_scc0 L_no33
    s_call_b64 s[6:7], L_bo
L_no33:
    s_mov_b32 s64, 40960
    buffer_load_dwordx4 v[84:87], v1, s[36:39], s64 offen nt
    v_and_b32_dpp v8, v20, v4 row_newbcast:2 row_mask:0xf bank_mask:0xf
    v_and_b32_dpp v9, v20, v5 row_newbcast:2 row_mask:0xf bank_mask:0xf
    v_and_b32_dpp v10, v20, v6 row_newbcast:2 row_mask:0xf bank_mask:0xf
    v_and_b32_dpp v11, v20, v7 row_newbcast:2 row_mask:0xf bank_mask:0xf
    s_waitcnt vmcnt(3)
    s_nop 0
    v_mfma_f32_16x16x32_bf16 v[12:15], v[8:11], v[72:75], v[12:15]
    s_cmp_eq_u32 s15, 34
    s_cbranch_scc0 L_no34
    s_call_b64 s[6:7], L_bo
L_no34:
    s_mov_b32 s64, 49152
    buffer_load_dwordx4 v[88:91], v1, s[36:39], s64 offen nt
    v_and_b32_dpp v8, v20, v4 row_newbcast:3 row_mask:0xf bank_mask:0xf
    v_and_b32_dpp v9, v20, v5 row_newbcast:3 row_mask:0xf bank_mask:0xf
    v_and_b32_dpp v10, v20, v6 row_newbcast:3 row_mask:0xf bank_mask:0xf
    v_and_b32_dpp v11, v20, v7 row_newbcast:3 row_mask:0xf bank_mask:0xf
    s_waitcnt vmcnt(3)
    s_nop 0
    v_mfma_f32_16x16x32_bf16 v[12:15], v[8:11], v[76:79], v[12:15]
    s_cmp_eq_u32 s15, 35
    s_cbranch_scc0 L_no35
    s_call_b64 s[6:7], L_bo
L_no35:
    s_mov_b32 s64, 57344
    buffer_load_dwordx4 v[92:95], v1, s[36:39], s64 offen nt
    v_and_b32 v22, 3, v124
    v_lshrrev_b32 v23, 2, v124
    v_mul_u32_u24 v115, 0x5555, v22
    v_and_b32 v24, 1, v123
    v_mul_u32_u24 v104, 272, v24
    v_lshrrev_b32 v24, 1, v124
    v_lshl_add_u32 v104, v24, 5, v104
    v_lshrrev_b32 v24, 1, v123
    v_lshl_add_u32 v104, v24, 4, v104
    v_and_b32 v24, 1, v124
    v_lshl_add_u32 v104, v24, 3, v104
    s_lshl_b32 s65, s30, 8
    v_mov_b32 v40, 0
    v_mov_b32 v41, 0
    v_mov_b32 v42, 0
    v_mov_b32 v43, 0
    v_mov_b32 v44, 0
    v_mov_b32 v45, 0
    v_mov_b32 v46, 0
    v_mov_b32 v47, 0
    v_lshrrev_b32 v24, 5, v122
    v_and_b32 v25, 7, v122
    v_lshrrev_b32 v26, 3, v122
    v_mov_b32 v27, 2147483648
    s_and_b32 s64, s68, 3
    s_lshl_b32 s64, s64, 4
    s_lshr_b32 s10, s69, 1
    s_add_u32 s64, s64, s10
    s_lshr_b32 s10, s68, 2
    s_lshl1_add_u32 s64, s64, s10
    s_xor_b32 s64, s64, 0
    s_and_b32 s10, s69, 1
    s_lshl1_add_u32 s64, s64, s10
    s_lshl_b32 s64, s64, 12
    s_add_u32 s64, s64, s65
    v_lshl_add_u32 v60, v122, 4, s64
    s_add_u32 s0, s0, 2654435761
    s_and_b32 s14, s0, 15
    v_mov_b32 v117, 0xfffffff0
    s_min_u32 s64, s31, 3
    s_mul_i32 s65, s31, 3
    s_add_u32 s64, s64, s65
    s_mul_i32 s10, s3, 43
    s_lshr_b32 s10, s10, 7
    s_lshr_b32 s11, s3, 2
    s_cmp_lt_u32 s31, 3
    s_cselect_b32 s10, s11, s10
    s_cselect_b32 s11, 4, 3
    s_cselect_b32 s12, 23, 18
    s_mul_i32 s11, s11, s10
    s_sub_u32 s11, s3, s11
    s_add_u32 s64, s64, s11
    s_lshl_b32 s64, s64, 7
    s_and_b32 s65, s30, 3
    s_lshl2_add_u32 s65, s10, s65
    s_mul_i32 s65, s65, s12
    v_add_u32 v28, s65, v122
    v_bfe_u32 v29, v28, 5, 2
    v_mul_u32_u24 v29, 160, v29
    v_lshrrev_b32 v30, 7, v28
    v_lshl_add_u32 v29, v30, 5, v29
    v_and_b32 v2, 31, v28
    v_add_u32 v2, v2, v29
    v_mul_u32_u24 v2, 3456, v2
    v_add_u32 v2, s64, v2
    s_bfm_b32 vcc_lo, s12, 0
    s_mov_b32 vcc_hi, 0
    v_cmp_gt_u32 s[10:11], 5, v30
    s_nop 0
    s_and_b32 vcc_lo, vcc_lo, s10
    v_cndmask_b32 v2, v27, v2, vcc
    s_cmp_lt_u32 s30, 4
    s_cselect_b32 s40, s18, s20
    s_cselect_b32 s41, s19, s21
    s_mov_b32 s42, 2211840
    s_mov_b32 s48, s22
    s_mov_b32 s49, s23
    s_mov_b32 s50, 2211840
    s_cmp_lt_u32 s31, 3
    s_cselect_b32 s64, 16, 12
    s_cselect_b32 s11, 18, 14
    s_mov_b32 s10, 108
    s_cselect_b32 s10, 144, s10
    s_sub_u32 s64, s3, s64
    s_mul_i32 s64, s64, s10
    s_mul_i32 s65, s30, s11
    s_add_u32 s64, s64, s65
    s_mul_i32 s64, s64, 1280
    v_lshrrev_b32 v28, 1, v122
    v_mul_u32_u24 v63, 1280, v28
    s_lshl_b32 s65, s31, 7
    s_add_u32 s65, s65, s64
    s_lshr_b32 s10, s31, 1
    s_add_u32 s10, s10, 6
    s_lshl_b32 s10, s10, 7
    s_add_u32 s10, s10, s64
    v_mov_b32 v28, s65
    v_mov_b32 v29, s10
    s_mov_b32 vcc_lo, 0xaaaaaaaa
    v_cndmask_b32 v28, v28, v29, vcc
    v_add_u32 v63, v63, v28
    s_cmp_ge_u32 s31, 4
    s_mov_b32 vcc_lo, 1431655765
    s_cselect_b32 vcc_lo, 268435455, vcc_lo
    s_cselect_b32 vcc_hi, 0, 5
    v_cndmask_b32 v63, v27, v63, vcc
    s_mov_b32 s9, 0x200000
    s_mov_b32 s59, 0x20000
    s_mov_b32 s63, 0x20000
    s_lshr_b32 s64, s31, 3
    s_xor_b32 s64, s64, 0
    s_lshl_b32 s64, s64, 13
    s_add_u32 s64, s64, 1179648
    s_and_b32 s65, s31, 0
    s_lshl_b32 s65, s65, 16
    s_add_u32 s64, s64, s65
    s_add_u32 s60, s28, s64
    s_addc_u32 s61, s29, 0
    s_mov_b32 s62, 52224
    s_cmp_eq_u32 s66, 3
    s_cbranch_scc0 L_t_mlp
    v_mov_b32 v2, 2147483648
    v_mov_b32 v63, 2147483648
    s_and_b32 s64, s31, 3
    s_lshl_b32 s64, s64, 4
    s_lshr_b32 s65, s31, 2
    s_lshl1_add_u32 s64, s64, s65
    s_xor_b32 s64, s64, 0
    s_lshl_b32 s64, s64, 13
    s_lshl_b32 s65, s67, 7
    s_add_u32 s64, s64, s65
    v_lshl_add_u32 v105, v25, 4, s64
    v_lshl_add_u32 v105, v123, 14, v105
    v_and_b32 v28, 1, v26
    v_lshl_add_u32 v105, v28, 12, v105
    s_min_u32 s65, s67, 19
    s_and_b32 s10, s65, 1
    s_lshl_b32 s65, s65, 6
    s_mul_i32 s10, s10, 56
    s_sub_u32 s65, s65, s10
    s_mul_i32 s64, s31, 1280
    s_add_u32 s64, s64, s65
    v_lshl_add_u32 v112, v25, 3, v123
    v_lshl_add_u32 v112, v112, 1, s64
    s_mov_b32 s10, 65536
    s_mov_b32 s11, 131072
    s_mov_b32 s12, 196608
    s_mov_b32 s56, s28
    s_mov_b32 s57, s29
    s_mov_b32 s58, 0
    s_branch L_t_done
L_t_mlp:
    s_mul_i32 s65, s30, 5120
    s_add_u32 s65, s65, 40960
    v_lshl_add_u32 v105, v122, 4, s65
    s_and_b32 s64, s31, 3
    s_lshr_b32 s10, s30, 2
    s_lshl1_add_u32 s64, s64, s10
    s_lshr_b32 s10, s31, 3
    s_lshl1_add_u32 s64, s64, s10
    s_xor_b32 s64, s64, 0
    s_lshl_b32 s64, s64, 13
    s_and_b32 s13, s30, 3
    s_mul_i32 s10, s13, 1280
    s_add_u32 s64, s64, s10
    s_add_u32 s64, s64, 1048576
    v_lshl_add_u32 v112, v122, 4, s64
    v_lshl_add_u32 v113, v122, 2, s64
    s_mul_i32 s64, s30, 1344
    s_add_u32 s64, s64, 8192
    v_lshl_add_u32 v114, v122, 4, s64
    v_lshl_add_u32 v118, v122, 2, s64
    v_lshl_add_u32 v121, v24, 4, v25
    v_and_b32 v27, 3, v26
    v_lshlrev_b32 v27, 2, v27
    v_lshl_add_u32 v121, v121, 4, v27
    v_add_u32 v121, 32768, v121
    s_cmp_eq_u32 s66, 1
    s_cbranch_scc0 L_t_s2
    v_mov_b32 v63, 2147483648
    s_mov_b32 s56, s40
    s_mov_b32 s57, s41
    s_mov_b32 s58, 2211840
    s_mul_i32 s10, s13, 5
    s_and_b32 s11, s10, 1
    s_lshl_b32 s10, s10, 5
    s_mul_i32 s12, s11, 28
    s_sub_u32 s10, s10, s12
    s_mul_i32 s64, s10, 3456
    s_lshl_b32 s10, s67, 5
    s_add_u32 s64, s64, s10
    v_bfe_u32 v27, v122, 1, 2
    v_lshl_add_u32 v27, v26, 3, v27
    v_mul_u32_u24 v27, 3456, v27
    v_xor_b32 v28, v122, v123
    v_and_b32 v28, 1, v28
    v_lshl_add_u32 v27, v28, 4, v27
    v_add_u32 v62, s64, v27
    v_and_b32 v28, 1, v122
    s_and_b32 s64, s30, 4
    s_lshl_b32 s64, s64, 4
    v_add_u32 v105, s64, v105
    v_lshlrev_b32 v119, 4, v24
    v_and_b32 v27, 1, v123
    v_lshl_add_u32 v119, v27, 2, v119
    v_lshrrev_b32 v27, 1, v23
    v_lshl_add_u32 v119, v27, 3, v119
    v_and_b32 v29, 1, v23
    v_add_lshl_u32 v119, v119, v29, 5
    v_lshl_add_u32 v119, v28, 3, v119
    v_lshrrev_b32 v29, 1, v22
    v_mul_u32_u24 v29, 20544, v29
    v_add_u32 v119, v119, v29
    v_xor_b32 v29, s30, v27
    v_and_b32 v29, 1, v29
    v_lshl_add_u32 v119, v29, 4, v119
    v_add_u32 v119, 40960, v119
    v_mul_u32_u24 v120, 1344, v25
    v_lshl_add_u32 v120, v123, 5, v120
    v_lshl_add_u32 v120, v27, 4, v120
    v_mul_u32_u24 v121, 0xaaaa, v27
    v_add_u32 v121, 0x4444, v121
    s_mul_i32 s10, s11, 193536
    s_add_u32 s10, s10, 13824
    s_mov_b32 s11, 221184
    s_add_u32 s12, s10, s11
    s_mov_b32 s13, 442368
    s_branch L_t_done
L_t_s2:
    s_mov_b32 s56, s22
    s_mov_b32 s57, s23
    s_mov_b32 s58, 2211840
    s_lshl_b32 s64, s67, 4
    v_mul_u32_u24 v27, 1280, v0
    v_add_u32 v62, s64, v27
    v_lshrrev_b32 v119, 1, v22
    v_lshl_add_u32 v119, v123, 1, v119
    v_lshl_add_u32 v119, v119, 3, v23
    v_lshlrev_b32 v119, 4, v119
    v_and_b32 v28, 1, v22
    v_lshl_add_u32 v119, v28, 3, v119
    v_add_u32 v119, s65, v119
    v_mul_u32_u24 v120, 1344, v26
    v_lshl_add_u32 v120, v22, 1, v120
    v_and_b32 v28, 1, v23
    v_lshl_add_u32 v120, v28, 6, v120
    s_and_b32 s10, s67, 7
    s_lshl_b32 s10, s10, 3
    s_sub_u32 s10, s64, s10
    v_add_u32 v120, s10, v120
    v_mul_u32_u24 v127, 1280, v26
    v_add_u32 v127, s64, v127
    v_lshl_add_u32 v127, v25, 1, v127
    s_mov_b32 s10, 655360
    s_mov_b32 s11, 1310720
    s_mov_b32 s12, 1966080
    s_mov_b32 s13, 2147483648
L_t_done:
    s_nop 1
    v_and_b32_dpp v8, v20, v4 row_newbcast:4 row_mask:0xf bank_mask:0xf
    v_and_b32_dpp v9, v20, v5 row_newbcast:4 row_mask:0xf bank_mask:0xf
    v_and_b32_dpp v10, v20, v6 row_newbcast:4 row_mask:0xf bank_mask:0xf
    v_and_b32_dpp v11, v20, v7 row_newbcast:4 row_mask:0xf bank_mask:0xf
    s_waitcnt vmcnt(3)
    s_nop 0
    v_mfma_f32_16x16x32_bf16 v[12:15], v[8:11], v[80:83], v[12:15]
    s_cmp_eq_u32 s15, 36
    s_cbranch_scc0 L_no36
    s_call_b64 s[6:7], L_bo
L_no36:
    s_mov_b32 s64, 65536
    buffer_load_dwordx4 v[64:67], v1, s[36:39], s64 offen nt
    v_and_b32_dpp v8, v20, v4 row_newbcast:5 row_mask:0xf bank_mask:0xf
    v_and_b32_dpp v9, v20, v5 row_newbcast:5 row_mask:0xf bank_mask:0xf
    v_and_b32_dpp v10, v20, v6 row_newbcast:5 row_mask:0xf bank_mask:0xf
    v_and_b32_dpp v11, v20, v7 row_newbcast:5 row_mask:0xf bank_mask:0xf
    s_waitcnt vmcnt(3)
    s_nop 0
    v_mfma_f32_16x16x32_bf16 v[12:15], v[8:11], v[84:87], v[12:15]
    s_cmp_eq_u32 s15, 37
    s_cbranch_scc0 L_no37
    s_call_b64 s[6:7], L_bo
L_no37:
    s_mov_b32 s64, 73728
    buffer_load_dwordx4 v[68:71], v1, s[36:39], s64 offen nt
    v_and_b32_dpp v8, v20, v4 row_newbcast:6 row_mask:0xf bank_mask:0xf
    v_and_b32_dpp v9, v20, v5 row_newbcast:6 row_mask:0xf bank_mask:0xf
    v_and_b32_dpp v10, v20, v6 row_newbcast:6 row_mask:0xf bank_mask:0xf
    v_and_b32_dpp v11, v20, v7 row_newbcast:6 row_mask:0xf bank_mask:0xf
    s_waitcnt vmcnt(3)
    s_nop 0
    v_mfma_f32_16x16x32_bf16 v[12:15], v[8:11], v[88:91], v[12:15]
    s_cmp_eq_u32 s15, 38
    s_cbranch_scc0 L_no38
    s_call_b64 s[6:7], L_bo
L_no38:
    s_mov_b32 s64, 81920
    buffer_load_dwordx4 v[72:75], v1, s[36:39], s64 offen nt
    v_and_b32_dpp v8, v20, v4 row_newbcast:7 row_mask:0xf bank_mask:0xf
    v_and_b32_dpp v9, v20, v5 row_newbcast:7 row_mask:0xf bank_mask:0xf
    v_and_b32_dpp v10, v20, v6 row_newbcast:7 row_mask:0xf bank_mask:0xf
    v_and_b32_dpp v11, v20, v7 row_newbcast:7 row_mask:0xf bank_mask:0xf
    s_waitcnt vmcnt(3)
    s_nop 0
    v_mfma_f32_16x16x32_bf16 v[12:15], v[8:11], v[92:95], v[12:15]
    s_cmp_eq_u32 s15, 39
    s_cbranch_scc0 L_no39
    s_call_b64 s[6:7], L_bo
L_no39:
    s_mov_b32 s64, 90112
    buffer_load_dwordx4 v[76:79], v1, s[36:39], s64 offen nt
    v_and_b32_dpp v8, v20, v4 row_newbcast:8 row_mask:0xf bank_mask:0xf
    v_and_b32_dpp v9, v20, v5 row_newbcast:8 row_mask:0xf bank_mask:0xf
    v_and_b32_dpp v10, v20, v6 row_newbcast:8 row_mask:0xf bank_mask:0xf
    v_and_b32_dpp v11, v20, v7 row_newbcast:8 row_mask:0xf bank_mask:0xf
    s_waitcnt vmcnt(3)
    s_nop 0
    v_mfma_f32_16x16x32_bf16 v[12:15], v[8:11], v[64:67], v[12:15]
    s_cmp_eq_u32 s15, 40
    s_cbranch_scc0 L_no40
    s_call_b64 s[6:7], L_bo
L_no40:
    s_mov_b32 s64, 98304
    buffer_load_dwordx4 v[80:83], v1, s[36:39], s64 offen nt
    v_and_b32_dpp v8, v20, v4 row_newbcast:9 row_mask:0xf bank_mask:0xf
    v_and_b32_dpp v9, v20, v5 row_newbcast:9 row_mask:0xf bank_mask:0xf
    v_and_b32_dpp v10, v20, v6 row_newbcast:9 row_mask:0xf bank_mask:0xf
    v_and_b32_dpp v11, v20, v7 row_newbcast:9 row_mask:0xf bank_mask:0xf
    s_waitcnt vmcnt(3)
    s_nop 0
    v_mfma_f32_16x16x32_bf16 v[12:15], v[8:11], v[68:71], v[12:15]
    s_cmp_eq_u32 s15, 41
    s_cbranch_scc0 L_no41
    s_call_b64 s[6:7], L_bo
L_no41:
    s_mov_b32 s64, 106496
    buffer_load_dwordx4 v[84:87], v1, s[36:39], s64 offen nt
    v_and_b32_dpp v8, v20, v4 row_newbcast:10 row_mask:0xf bank_mask:0xf
    v_and_b32_dpp v9, v20, v5 row_newbcast:10 row_mask:0xf bank_mask:0xf
    v_and_b32_dpp v10, v20, v6 row_newbcast:10 row_mask:0xf bank_mask:0xf
    v_and_b32_dpp v11, v20, v7 row_newbcast:10 row_mask:0xf bank_mask:0xf
    s_waitcnt vmcnt(3)
    s_nop 0
    v_mfma_f32_16x16x32_bf16 v[12:15], v[8:11], v[72:75], v[12:15]
    s_cmp_eq_u32 s15, 42
    s_cbranch_scc0 L_no42
    s_call_b64 s[6:7], L_bo
L_no42:
    s_mov_b32 s64, 114688
    buffer_load_dwordx4 v[88:91], v1, s[36:39], s64 offen nt
    v_and_b32_dpp v8, v20, v4 row_newbcast:11 row_mask:0xf bank_mask:0xf
    v_and_b32_dpp v9, v20, v5 row_newbcast:11 row_mask:0xf bank_mask:0xf
    v_and_b32_dpp v10, v20, v6 row_newbcast:11 row_mask:0xf bank_mask:0xf
    v_and_b32_dpp v11, v20, v7 row_newbcast:11 row_mask:0xf bank_mask:0xf
    s_waitcnt vmcnt(3)
    s_nop 0
    v_mfma_f32_16x16x32_bf16 v[12:15], v[8:11], v[76:79], v[12:15]
    s_cmp_eq_u32 s15, 43
    s_cbranch_scc0 L_no43
    s_call_b64 s[6:7], L_bo
L_no43:
    s_mov_b32 s64, 122880
    buffer_load_dwordx4 v[92:95], v1, s[36:39], s64 offen nt
    v_and_b32_dpp v8, v20, v4 row_newbcast:12 row_mask:0xf bank_mask:0xf
    v_and_b32_dpp v9, v20, v5 row_newbcast:12 row_mask:0xf bank_mask:0xf
    v_and_b32_dpp v10, v20, v6 row_newbcast:12 row_mask:0xf bank_mask:0xf
    v_and_b32_dpp v11, v20, v7 row_newbcast:12 row_mask:0xf bank_mask:0xf
    s_waitcnt vmcnt(3)
    s_nop 0
    v_mfma_f32_16x16x32_bf16 v[12:15], v[8:11], v[80:83], v[12:15]
    s_cmp_eq_u32 s15, 44
    s_cbranch_scc0 L_no44
    s_call_b64 s[6:7], L_bo
L_no44:
    s_mov_b32 s64, 131072
    buffer_load_dwordx4 v[64:67], v1, s[36:39], s64 offen nt
    v_and_b32_dpp v8, v20, v4 row_newbcast:13 row_mask:0xf bank_mask:0xf
    v_and_b32_dpp v9, v20, v5 row_newbcast:13 row_mask:0xf bank_mask:0xf
    v_and_b32_dpp v10, v20, v6 row_newbcast:13 row_mask:0xf bank_mask:0xf
    v_and_b32_dpp v11, v20, v7 row_newbcast:13 row_mask:0xf bank_mask:0xf
    s_waitcnt vmcnt(3)
    s_nop 0
    v_mfma_f32_16x16x32_bf16 v[12:15], v[8:11], v[84:87], v[12:15]
    s_cmp_eq_u32 s15, 45
    s_cbranch_scc0 L_no45
    s_call_b64 s[6:7], L_bo
L_no45:
    s_mov_b32 s64, 139264
    buffer_load_dwordx4 v[68:71], v1, s[36:39], s64 offen nt
    v_and_b32_dpp v8, v20, v4 row_newbcast:14 row_mask:0xf bank_mask:0xf
    v_and_b32_dpp v9, v20, v5 row_newbcast:14 row_mask:0xf bank_mask:0xf
    v_and_b32_dpp v10, v20, v6 row_newbcast:14 row_mask:0xf bank_mask:0xf
    v_and_b32_dpp v11, v20, v7 row_newbcast:14 row_mask:0xf bank_mask:0xf
    s_waitcnt vmcnt(3)
    s_nop 0
    v_mfma_f32_16x16x32_bf16 v[12:15], v[8:11], v[88:91], v[12:15]
    s_cmp_eq_u32 s15, 46
    s_cbranch_scc0 L_no46
    s_call_b64 s[6:7], L_bo
L_no46:
    s_mov_b32 s64, 147456
    buffer_load_dwordx4 v[72:75], v1, s[36:39], s64 offen nt
    v_and_b32_dpp v8, v20, v4 row_newbcast:15 row_mask:0xf bank_mask:0xf
    v_and_b32_dpp v9, v20, v5 row_newbcast:15 row_mask:0xf bank_mask:0xf
    v_and_b32_dpp v10, v20, v6 row_newbcast:15 row_mask:0xf bank_mask:0xf
    v_and_b32_dpp v11, v20, v7 row_newbcast:15 row_mask:0xf bank_mask:0xf
    s_waitcnt vmcnt(3)
    s_nop 0
    v_mfma_f32_16x16x32_bf16 v[12:15], v[8:11], v[92:95], v[12:15]
    s_cmp_eq_u32 s15, 47
    s_cbranch_scc0 L_no47
    s_call_b64 s[6:7], L_bo
L_no47:
    s_mov_b32 s64, 155648
    buffer_load_dwordx4 v[76:79], v1, s[36:39], s64 offen nt
    v_and_b32_dpp v8, v21, v4 row_newbcast:0 row_mask:0xf bank_mask:0xf
    v_and_b32_dpp v9, v21, v5 row_newbcast:0 row_mask:0xf bank_mask:0xf
    v_and_b32_dpp v10, v21, v6 row_newbcast:0 row_mask:0xf bank_mask:0xf
    v_and_b32_dpp v11, v21, v7 row_newbcast:0 row_mask:0xf bank_mask:0xf
    s_waitcnt vmcnt(3)
    s_nop 0
    v_mfma_f32_16x16x32_bf16 v[12:15], v[8:11], v[64:67], v[12:15]
    s_cmp_eq_u32 s15, 48
    s_cbranch_scc0 L_no48
    s_call_b64 s[6:7], L_bo
L_no48:
    s_mov_b32 s64, 163840
    buffer_load_dwordx4 v[80:83], v1, s[36:39], s64 offen nt
    v_and_b32_dpp v8, v21, v4 row_newbcast:1 row_mask:0xf bank_mask:0xf
    v_and_b32_dpp v9, v21, v5 row_newbcast:1 row_mask:0xf bank_mask:0xf
    v_and_b32_dpp v10, v21, v6 row_newbcast:1 row_mask:0xf bank_mask:0xf
    v_and_b32_dpp v11, v21, v7 row_newbcast:1 row_mask:0xf bank_mask:0xf
    s_waitcnt vmcnt(3)
    s_nop 0
    v_mfma_f32_16x16x32_bf16 v[12:15], v[8:11], v[68:71], v[12:15]
    s_cmp_eq_u32 s15, 49
    s_cbranch_scc0 L_no49
    s_call_b64 s[6:7], L_bo
L_no49:
    s_mov_b32 s64, 172032
    buffer_load_dwordx4 v[84:87], v1, s[36:39], s64 offen nt
    v_and_b32_dpp v8, v21, v4 row_newbcast:2 row_mask:0xf bank_mask:0xf
    v_and_b32_dpp v9, v21, v5 row_newbcast:2 row_mask:0xf bank_mask:0xf
    v_and_b32_dpp v10, v21, v6 row_newbcast:2 row_mask:0xf bank_mask:0xf
    v_and_b32_dpp v11, v21, v7 row_newbcast:2 row_mask:0xf bank_mask:0xf
    s_waitcnt vmcnt(3)
    s_nop 0
    v_mfma_f32_16x16x32_bf16 v[12:15], v[8:11], v[72:75], v[12:15]
    s_cmp_eq_u32 s15, 50
    s_cbranch_scc0 L_no50
    s_call_b64 s[6:7], L_bo
L_no50:
    s_mov_b32 s64, 180224
    buffer_load_dwordx4 v[88:91], v1, s[36:39], s64 offen nt
    v_and_b32_dpp v8, v21, v4 row_newbcast:3 row_mask:0xf bank_mask:0xf
    v_and_b32_dpp v9, v21, v5 row_newbcast:3 row_mask:0xf bank_mask:0xf
    v_and_b32_dpp v10, v21, v6 row_newbcast:3 row_mask:0xf bank_mask:0xf
    v_and_b32_dpp v11, v21, v7 row_newbcast:3 row_mask:0xf bank_mask:0xf
    s_waitcnt vmcnt(3)
    s_nop 0
    v_mfma_f32_16x16x32_bf16 v[12:15], v[8:11], v[76:79], v[12:15]
    s_cmp_eq_u32 s15, 51
    s_cbranch_scc0 L_no51
    s_call_b64 s[6:7], L_bo
L_no51:
    s_mov_b32 s64, 188416
    buffer_load_dwordx4 v[92:95], v1, s[36:39], s64 offen nt
    v_and_b32_dpp v8, v21, v4 row_newbcast:4 row_mask:0xf bank_mask:0xf
    v_and_b32_dpp v9, v21, v5 row_newbcast:4 row_mask:0xf bank_mask:0xf
    v_and_b32_dpp v10, v21, v6 row_newbcast:4 row_mask:0xf bank_mask:0xf
    v_and_b32_dpp v11, v21, v7 row_newbcast:4 row_mask:0xf bank_mask:0xf
    s_waitcnt vmcnt(3)
    s_nop 0
    v_mfma_f32_16x16x32_bf16 v[12:15], v[8:11], v[80:83], v[12:15]
    s_cmp_eq_u32 s15, 52
    s_cbranch_scc0 L_no52
    s_call_b64 s[6:7], L_bo
L_no52:
    s_mov_b32 s64, 196608
    buffer_load_dwordx4 v[64:67], v1, s[36:39], s64 offen nt
    v_and_b32_dpp v8, v21, v4 row_newbcast:5 row_mask:0xf bank_mask:0xf
    v_and_b32_dpp v9, v21, v5 row_newbcast:5 row_mask:0xf bank_mask:0xf
    v_and_b32_dpp v10, v21, v6 row_newbcast:5 row_mask:0xf bank_mask:0xf
    v_and_b32_dpp v11, v21, v7 row_newbcast:5 row_mask:0xf bank_mask:0xf
    s_waitcnt vmcnt(3)
    s_nop 0
    v_mfma_f32_16x16x32_bf16 v[12:15], v[8:11], v[84:87], v[12:15]
    s_cmp_eq_u32 s15, 53
    s_cbranch_scc0 L_no53
    s_call_b64 s[6:7], L_bo
L_no53:
    s_mov_b32 s64, 204800
    buffer_load_dwordx4 v[68:71], v1, s[36:39], s64 offen nt
    v_and_b32_dpp v8, v21, v4 row_newbcast:6 row_mask:0xf bank_mask:0xf
    v_and_b32_dpp v9, v21, v5 row_newbcast:6 row_mask:0xf bank_mask:0xf
    v_and_b32_dpp v10, v21, v6 row_newbcast:6 row_mask:0xf bank_mask:0xf
    v_and_b32_dpp v11, v21, v7 row_newbcast:6 row_mask:0xf bank_mask:0xf
    s_waitcnt vmcnt(3)
    s_nop 0
    v_mfma_f32_16x16x32_bf16 v[12:15], v[8:11], v[88:91], v[12:15]
    s_cmp_eq_u32 s15, 54
    s_cbranch_scc0 L_no54
    s_call_b64 s[6:7], L_bo
L_no54:
    s_mov_b32 s64, 212992
    buffer_load_dwordx4 v[72:75], v1, s[36:39], s64 offen nt
    v_and_b32_dpp v8, v21, v4 row_newbcast:7 row_mask:0xf bank_mask:0xf
    v_and_b32_dpp v9, v21, v5 row_newbcast:7 row_mask:0xf bank_mask:0xf
    v_and_b32_dpp v10, v21, v6 row_newbcast:7 row_mask:0xf bank_mask:0xf
    v_and_b32_dpp v11, v21, v7 row_newbcast:7 row_mask:0xf bank_mask:0xf
    s_waitcnt vmcnt(3)
    s_nop 0
    v_mfma_f32_16x16x32_bf16 v[12:15], v[8:11], v[92:95], v[12:15]
    s_cmp_eq_u32 s15, 55
    s_cbranch_scc0 L_no55
    s_call_b64 s[6:7], L_bo
L_no55:
    s_mov_b32 s64, 221184
    buffer_load_dwordx4 v[76:79], v1, s[36:39], s64 offen nt
    v_and_b32_dpp v8, v21, v4 row_newbcast:8 row_mask:0xf bank_mask:0xf
    v_and_b32_dpp v9, v21, v5 row_newbcast:8 row_mask:0xf bank_mask:0xf
    v_and_b32_dpp v10, v21, v6 row_newbcast:8 row_mask:0xf bank_mask:0xf
    v_and_b32_dpp v11, v21, v7 row_newbcast:8 row_mask:0xf bank_mask:0xf
    s_waitcnt vmcnt(3)
    s_nop 0
    v_mfma_f32_16x16x32_bf16 v[12:15], v[8:11], v[64:67], v[12:15]
    s_cmp_eq_u32 s15, 56
    s_cbranch_scc0 L_no56
    s_call_b64 s[6:7], L_bo
L_no56:
    s_load_dword s1, s[26:27], 0x0
    s_mov_b32 s64, 229376
    buffer_load_dwordx4 v[80:83], v1, s[36:39], s64 offen nt
    v_and_b32_dpp v8, v21, v4 row_newbcast:9 row_mask:0xf bank_mask:0xf
    v_and_b32_dpp v9, v21, v5 row_newbcast:9 row_mask:0xf bank_mask:0xf
    v_and_b32_dpp v10, v21, v6 row_newbcast:9 row_mask:0xf bank_mask:0xf
    v_and_b32_dpp v11, v21, v7 row_newbcast:9 row_mask:0xf bank_mask:0xf
    s_waitcnt vmcnt(3)
    s_nop 0
    v_mfma_f32_16x16x32_bf16 v[12:15], v[8:11], v[68:71], v[12:15]
    s_mov_b32 s64, 237568
    buffer_load_dwordx4 v[84:87], v1, s[36:39], s64 offen nt
    v_and_b32_dpp v8, v21, v4 row_newbcast:10 row_mask:0xf bank_mask:0xf
    v_and_b32_dpp v9, v21, v5 row_newbcast:10 row_mask:0xf bank_mask:0xf
    v_and_b32_dpp v10, v21, v6 row_newbcast:10 row_mask:0xf bank_mask:0xf
    v_and_b32_dpp v11, v21, v7 row_newbcast:10 row_mask:0xf bank_mask:0xf
    s_waitcnt vmcnt(3)
    s_nop 0
    v_mfma_f32_16x16x32_bf16 v[12:15], v[8:11], v[72:75], v[12:15]
    s_mov_b32 s64, 245760
    buffer_load_dwordx4 v[88:91], v1, s[36:39], s64 offen nt
    v_and_b32_dpp v8, v21, v4 row_newbcast:11 row_mask:0xf bank_mask:0xf
    v_and_b32_dpp v9, v21, v5 row_newbcast:11 row_mask:0xf bank_mask:0xf
    v_and_b32_dpp v10, v21, v6 row_newbcast:11 row_mask:0xf bank_mask:0xf
    v_and_b32_dpp v11, v21, v7 row_newbcast:11 row_mask:0xf bank_mask:0xf
    s_waitcnt vmcnt(3)
    s_nop 0
    v_mfma_f32_16x16x32_bf16 v[12:15], v[8:11], v[76:79], v[12:15]
    s_mov_b32 s64, 253952
    buffer_load_dwordx4 v[92:95], v1, s[36:39], s64 offen nt
    v_mov_b32 v22, v182
    v_mov_b32 v23, v183
    v_mov_b32_dpp v182, v180 row_ror:8 row_mask:0xf bank_mask:0x3
    v_mov_b32_dpp v183, v181 row_ror:8 row_mask:0xf bank_mask:0x3
    v_mov_b32_dpp v180, v22 row_ror:8 row_mask:0xf bank_mask:0xc
    v_mov_b32_dpp v181, v23 row_ror:8 row_mask:0xf bank_mask:0xc
    v_mov_b32 v22, v186
    v_mov_b32 v23, v187
    v_mov_b32_dpp v186, v184 row_ror:8 row_mask:0xf bank_mask:0x3
    v_mov_b32_dpp v187, v185 row_ror:8 row_mask:0xf bank_mask:0x3
    v_mov_b32_dpp v184, v22 row_ror:8 row_mask:0xf bank_mask:0xc
    v_mov_b32_dpp v185, v23 row_ror:8 row_mask:0xf bank_mask:0xc
    v_mov_b32 v22, v190
    v_mov_b32 v23, v191
    v_mov_b32_dpp v190, v188 row_ror:8 row_mask:0xf bank_mask:0x3
    v_mov_b32_dpp v191, v189 row_ror:8 row_mask:0xf bank_mask:0x3
    v_mov_b32_dpp v188, v22 row_ror:8 row_mask:0xf bank_mask:0xc
    v_mov_b32_dpp v189, v23 row_ror:8 row_mask:0xf bank_mask:0xc
    s_cmp_lt_u32 s30, 2
    s_cbranch_scc0 L_nox2
    v_mov_b32 v22, v246
    v_mov_b32 v23, v247
    v_mov_b32_dpp v246, v244 row_ror:8 row_mask:0xf bank_mask:0x3
    v_mov_b32_dpp v247, v245 row_ror:8 row_mask:0xf bank_mask:0x3
    v_mov_b32_dpp v244, v22 row_ror:8 row_mask:0xf bank_mask:0xc
    v_mov_b32_dpp v245, v23 row_ror:8 row_mask:0xf bank_mask:0xc
    v_mov_b32 v22, v250
    v_mov_b32 v23, v251
    v_mov_b32_dpp v250, v248 row_ror:8 row_mask:0xf bank_mask:0x3
    v_mov_b32_dpp v251, v249 row_ror:8 row_mask:0xf bank_mask:0x3
    v_mov_b32_dpp v248, v22 row_ror:8 row_mask:0xf bank_mask:0xc
    v_mov_b32_dpp v249, v23 row_ror:8 row_mask:0xf bank_mask:0xc
    v_mov_b32 v22, v254
    v_mov_b32 v23, v255
    v_mov_b32_dpp v254, v252 row_ror:8 row_mask:0xf bank_mask:0x3
    v_mov_b32_dpp v255, v253 row_ror:8 row_mask:0xf bank_mask:0x3
    v_mov_b32_dpp v252, v22 row_ror:8 row_mask:0xf bank_mask:0xc
    v_mov_b32_dpp v253, v23 row_ror:8 row_mask:0xf bank_mask:0xc
L_nox2:
    v_and_b32_dpp v8, v21, v4 row_newbcast:12 row_mask:0xf bank_mask:0xf
    v_and_b32_dpp v9, v21, v5 row_newbcast:12 row_mask:0xf bank_mask:0xf
    v_and_b32_dpp v10, v21, v6 row_newbcast:12 row_mask:0xf bank_mask:0xf
    v_and_b32_dpp v11, v21, v7 row_newbcast:12 row_mask:0xf bank_mask:0xf
    s_waitcnt vmcnt(3)
    s_nop 0
    v_mfma_f32_16x16x32_bf16 v[12:15], v[8:11], v[80:83], v[12:15]
    s_waitcnt lgkmcnt(0)
    s_mov_b32 s64, s1
    s_bitcmp1_b32 s64, 5
    s_cbranch_scc0 L_rdy_spin
L_ready:
    s_bfe_u32 s65, s64, 0xc0008
    s_cmp_gt_u32 s65, 64
    s_cselect_b32 s65, 15, 0
    s_lshr_b32 s64, s64, 24
    s_xor_b32 s64, s64, s65
    s_xor_b32 s8, s8, s65
    s_and_b32 s8, s8, 1
    s_lshl_b32 s8, s8, 13
    s_and_b32 s65, s68, 3
    s_lshr_b32 s65, s64, s65
    s_and_b32 s65, s65, 1
    s_lshl_b32 s65, s65, 13
    v_xor_b32 v60, s65, v60
    s_cmp_eq_u32 s66, 3
    s_cbranch_scc0 L_par_mlp
    s_and_b32 s65, s31, 3
    s_lshr_b32 s65, s64, s65
    s_and_b32 s65, s65, 1
    s_lshl_b32 s65, s65, 13
    v_xor_b32 v105, s65, v105
    s_xor_b32 s65, s8, 0x2000
    v_xor_b32 v61, s65, v61
    s_branch L_par_done
L_par_mlp:
    v_add_u32 v112, s8, v112
    v_add_u32 v113, s8, v113
    s_add_u32 s62, s62, s8
    s_mov_b32 s15, s8
L_par_done:
    v_and_b32_dpp v8, v21, v4 row_newbcast:13 row_mask:0xf bank_mask:0xf
    v_and_b32_dpp v9, v21, v5 row_newbcast:13 row_mask:0xf bank_mask:0xf
    v_and_b32_dpp v10, v21, v6 row_newbcast:13 row_mask:0xf bank_mask:0xf
    v_and_b32_dpp v11, v21, v7 row_newbcast:13 row_mask:0xf bank_mask:0xf
    s_waitcnt vmcnt(2)
    s_nop 0
    v_mfma_f32_16x16x32_bf16 v[12:15], v[8:11], v[84:87], v[12:15]
    s_cmp_eq_u32 s66, 3
    s_cselect_b32 s7, s67, 20
    s_cmp_lt_u32 s7, 20
    s_cselect_b32 s7, 1, 0
    v_and_b32_dpp v8, v21, v4 row_newbcast:14 row_mask:0xf bank_mask:0xf
    v_and_b32_dpp v9, v21, v5 row_newbcast:14 row_mask:0xf bank_mask:0xf
    v_and_b32_dpp v10, v21, v6 row_newbcast:14 row_mask:0xf bank_mask:0xf
    v_and_b32_dpp v11, v21, v7 row_newbcast:14 row_mask:0xf bank_mask:0xf
    s_waitcnt vmcnt(1)
    s_nop 0
    v_mfma_f32_16x16x32_bf16 v[12:15], v[8:11], v[88:91], v[12:15]
    v_and_b32_dpp v8, v21, v4 row_newbcast:15 row_mask:0xf bank_mask:0xf
    v_and_b32_dpp v9, v21, v5 row_newbcast:15 row_mask:0xf bank_mask:0xf
    v_and_b32_dpp v10, v21, v6 row_newbcast:15 row_mask:0xf bank_mask:0xf
    v_and_b32_dpp v11, v21, v7 row_newbcast:15 row_mask:0xf bank_mask:0xf
    s_waitcnt vmcnt(0)
    s_nop 0
    v_mfma_f32_16x16x32_bf16 v[12:15], v[8:11], v[92:95], v[12:15]
    buffer_load_dword v102, v2, s[40:43], 0 offen
L_tail:
    s_mov_b32 exec_hi, 0
    s_nop 5
    ds_write_b128 v116, v[12:15] offset:0
    s_mov_b32 exec_hi, -1
    s_waitcnt lgkmcnt(0)
    s_barrier
    ds_read_b64 v[64:65], v104 offset:0
    ds_read_b64 v[66:67], v104 offset:544
    ds_read_b64 v[68:69], v104 offset:1088
    ds_read_b64 v[70:71], v104 offset:1632
    ds_read_b64 v[72:73], v104 offset:2176
    ds_read_b64 v[74:75], v104 offset:2720
    ds_read_b64 v[76:77], v104 offset:3264
    ds_read_b64 v[78:79], v104 offset:3808
    s_cmp_eq_u32 s7, 1
    s_cbranch_scc1 L_red_early
L_red_back:
    s_cmp_lt_u32 s30, 2
    s_waitcnt lgkmcnt(6)
    v_pk_add_f32 v[64:65], v[64:65], v[66:67]
    s_waitcnt lgkmcnt(4)
    v_pk_add_f32 v[68:69], v[68:69], v[70:71]
    v_pk_add_f32 v[64:65], v[64:65], v[68:69]
    s_waitcnt lgkmcnt(2)
    v_pk_add_f32 v[72:73], v[72:73], v[74:75]
    s_waitcnt lgkmcnt(0)
    v_pk_add_f32 v[76:77], v[76:77], v[78:79]
    v_pk_add_f32 v[72:73], v[72:73], v[76:77]
    v_pk_add_f32 v[64:65], v[64:65], v[72:73]
    v_cvt_pk_bf16_f32 v20, 0, v64
    v_cvt_pk_bf16_f32 v21, 0, v65
    s_cbranch_scc1 L_op2
    s_nop 0
    v_mov_b64_dpp v[16:17], v[20:21] row_newbcast:0 row_mask:0xf bank_mask:0xf
    v_mov_b64_dpp v[18:19], v[20:21] row_newbcast:1 row_mask:0xf bank_mask:0xf
    v_mov_b64_dpp v[36:37], v[20:21] row_newbcast:2 row_mask:0xf bank_mask:0xf
    v_mov_b64_dpp v[38:39], v[20:21] row_newbcast:3 row_mask:0xf bank_mask:0xf
    v_smfmac_f32_16x16x64_bf16 v[40:43], v[16:19], v[128:135], v115
    v_mov_b64_dpp v[8:9], v[20:21] row_newbcast:4 row_mask:0xf bank_mask:0xf
    v_mov_b64_dpp v[10:11], v[20:21] row_newbcast:5 row_mask:0xf bank_mask:0xf
    v_smfmac_f32_16x16x64_bf16 v[40:43], v[36:39], v[136:143], v115
    v_mov_b64_dpp v[16:17], v[20:21] row_newbcast:6 row_mask:0xf bank_mask:0xf
    v_mov_b64_dpp v[18:19], v[20:21] row_newbcast:7 row_mask:0xf bank_mask:0xf
    v_smfmac_f32_16x16x64_bf16 v[40:43], v[8:11], v[144:151], v115
    v_mov_b64_dpp v[36:37], v[20:21] row_newbcast:8 row_mask:0xf bank_mask:0xf
    v_mov_b64_dpp v[38:39], v[20:21] row_newbcast:9 row_mask:0xf bank_mask:0xf
    v_smfmac_f32_16x16x64_bf16 v[40:43], v[16:19], v[152:159], v115
    v_mov_b64_dpp v[8:9], v[20:21] row_newbcast:10 row_mask:0xf bank_mask:0xf
    v_mov_b64_dpp v[10:11], v[20:21] row_newbcast:11 row_mask:0xf bank_mask:0xf
    v_smfmac_f32_16x16x64_bf16 v[40:43], v[36:39], v[160:167], v115
    v_mov_b64_dpp v[16:17], v[20:21] row_newbcast:12 row_mask:0xf bank_mask:0xf
    v_mov_b64_dpp v[18:19], v[20:21] row_newbcast:13 row_mask:0xf bank_mask:0xf
    v_smfmac_f32_16x16x64_bf16 v[40:43], v[8:11], v[168:175], v115
    v_mov_b64_dpp v[36:37], v[20:21] row_newbcast:14 row_mask:0xf bank_mask:0xf
    v_mov_b64_dpp v[38:39], v[20:21] row_newbcast:15 row_mask:0xf bank_mask:0xf
    v_smfmac_f32_16x16x64_bf16 v[40:43], v[16:19], v[176:183], v115
    s_nop 0
    v_smfmac_f32_16x16x64_bf16 v[40:43], v[36:39], v[184:191], v115
    s_mov_b64 exec, 0xffff
    s_nop 6
    v_and_or_b32 v64, v40, v117, s14
    v_and_or_b32 v65, v41, v117, s14
    v_and_or_b32 v66, v42, v117, s14
    v_and_or_b32 v67, v43, v117, s14
    buffer_store_dwordx4 v[64:67], v60, s[52:55], 0 offen offset:0 sc1
L_pub_done:
    s_mov_b64 exec, -1
    s_cmp_eq_u32 s66, 3
    s_cbranch_scc1 L_role3
    s_cmp_eq_u32 s66, 1
    s_barrier
    s_cbranch_scc1 L_role1
    buffer_load_dword v103, v63, s[48:51], 0 offen
    s_cmp_eq_u32 s66, 0
    s_cbranch_scc1 L_fin
    s_cmp_eq_u32 s66, 3
    s_cbranch_scc0 L_mlp
L_role3:
    s_cmp_lt_u32 s67, 20
    s_cbranch_scc0 L_fin
    s_waitcnt vmcnt(1)
    v_xor_b32 v40, s14, v80
    v_xor_b32 v41, s14, v81
    v_xor_b32 v42, s14, v82
    v_xor_b32 v43, s14, v83
    v_or3_b32 v25, v40, v41, v42
    v_or3_b32 v25, v25, v43, v117
    v_cmp_ne_u32 s[32:33], v25, v117
    s_nop 0
    s_or_b64 s[42:43], s[32:33], 1
    s_wqm_b64 exec, s[42:43]
    buffer_load_dwordx4 v[80:83], v105, s[52:55], 0 offen sc1
    s_mov_b64 exec, -1
    v_xor_b32 v44, s14, v84
    v_xor_b32 v45, s14, v85
    v_xor_b32 v46, s14, v86
    v_xor_b32 v47, s14, v87
    v_or3_b32 v25, v44, v45, v46
    v_or3_b32 v25, v25, v47, v117
    v_cmp_ne_u32 s[34:35], v25, v117
    s_nop 0
    s_or_b64 s[42:43], s[34:35], 1
    s_wqm_b64 exec, s[42:43]
    buffer_load_dwordx4 v[84:87], v105, s[52:55], s10 offen sc1
    s_mov_b64 exec, -1
    v_xor_b32 v48, s14, v88
    v_xor_b32 v49, s14, v89
    v_xor_b32 v50, s14, v90
    v_xor_b32 v51, s14, v91
    v_or3_b32 v25, v48, v49, v50
    v_or3_b32 v25, v25, v51, v117
    v_cmp_ne_u32 s[36:37], v25, v117
    s_nop 0
    s_or_b64 s[42:43], s[36:37], 1
    s_wqm_b64 exec, s[42:43]
    buffer_load_dwordx4 v[88:91], v105, s[52:55], s11 offen sc1
    s_mov_b64 exec, -1
    v_xor_b32 v52, s14, v92
    v_xor_b32 v53, s14, v93
    v_xor_b32 v54, s14, v94
    v_xor_b32 v55, s14, v95
    v_or3_b32 v25, v52, v53, v54
    v_or3_b32 v25, v25, v55, v117
    v_cmp_ne_u32 s[38:39], v25, v117
    s_nop 0
    s_or_b64 s[42:43], s[38:39], 1
    s_wqm_b64 exec, s[42:43]
    buffer_load_dwordx4 v[92:95], v105, s[52:55], s12 offen sc1
    s_mov_b64 exec, -1
    s_or_b64 s[40:41], s[32:33], s[34:35]
    s_or_b64 s[42:43], s[36:37], s[38:39]
    s_or_b64 s[40:41], s[40:41], s[42:43]
    s_cbranch_scc0 L_red_ok
L_red_poll:
    s_or_b64 s[40:41], s[34:35], s[36:37]
    s_or_b64 s[40:41], s[40:41], s[38:39]
    s_waitcnt vmcnt(3)
    v_xor_b32 v40, s14, v80
    v_xor_b32 v41, s14, v81
    v_xor_b32 v42, s14, v82
    v_xor_b32 v43, s14, v83
    v_or3_b32 v25, v40, v41, v42
    v_or3_b32 v25, v25, v43, v117
    v_cmp_ne_u32 s[32:33], v25, v117
    s_nop 0
    s_or_b64 s[40:41], s[40:41], s[32:33]
    s_cbranch_scc0 L_red_ok
    s_or_b64 s[42:43], s[32:33], 1
    s_wqm_b64 exec, s[42:43]
    buffer_load_dwordx4 v[80:83], v105, s[52:55], 0 offen sc1
    s_mov_b64 exec, -1
    s_or_b64 s[40:41], s[32:33], s[36:37]
    s_or_b64 s[40:41], s[40:41], s[38:39]
    s_waitcnt vmcnt(3)
    v_xor_b32 v44, s14, v84
    v_xor_b32 v45, s14, v85
    v_xor_b32 v46, s14, v86
    v_xor_b32 v47, s14, v87
    v_or3_b32 v25, v44, v45, v46
    v_or3_b32 v25, v25, v47, v117
    v_cmp_ne_u32 s[34:35], v25, v117
    s_nop 0
    s_or_b64 s[40:41], s[40:41], s[34:35]
    s_cbranch_scc0 L_red_ok
    s_or_b64 s[42:43], s[34:35], 1
    s_wqm_b64 exec, s[42:43]
    buffer_load_dwordx4 v[84:87], v105, s[52:55], s10 offen sc1
    s_mov_b64 exec, -1
    s_or_b64 s[40:41], s[32:33], s[34:35]
    s_or_b64 s[40:41], s[40:41], s[38:39]
    s_waitcnt vmcnt(3)
    v_xor_b32 v48, s14, v88
    v_xor_b32 v49, s14, v89
    v_xor_b32 v50, s14, v90
    v_xor_b32 v51, s14, v91
    v_or3_b32 v25, v48, v49, v50
    v_or3_b32 v25, v25, v51, v117
    v_cmp_ne_u32 s[36:37], v25, v117
    s_nop 0
    s_or_b64 s[40:41], s[40:41], s[36:37]
    s_cbranch_scc0 L_red_ok
    s_or_b64 s[42:43], s[36:37], 1
    s_wqm_b64 exec, s[42:43]
    buffer_load_dwordx4 v[88:91], v105, s[52:55], s11 offen sc1
    s_mov_b64 exec, -1
    s_or_b64 s[40:41], s[32:33], s[34:35]
    s_or_b64 s[40:41], s[40:41], s[36:37]
    s_waitcnt vmcnt(3)
    v_xor_b32 v52, s14, v92
    v_xor_b32 v53, s14, v93
    v_xor_b32 v54, s14, v94
    v_xor_b32 v55, s14, v95
    v_or3_b32 v25, v52, v53, v54
    v_or3_b32 v25, v25, v55, v117
    v_cmp_ne_u32 s[38:39], v25, v117
    s_nop 0
    s_or_b64 s[40:41], s[40:41], s[38:39]
    s_cbranch_scc0 L_red_ok
    s_or_b64 s[42:43], s[38:39], 1
    s_wqm_b64 exec, s[42:43]
    buffer_load_dwordx4 v[92:95], v105, s[52:55], s12 offen sc1
    s_mov_b64 exec, -1
    s_sub_u32 s9, s9, 1
    s_cbranch_scc0 L_red_poll
    s_branch L_fin
L_red_ok:
    v_pk_add_f32 v[72:73], v[40:41], v[44:45]
    v_pk_add_f32 v[76:77], v[48:49], v[52:53]
    v_pk_add_f32 v[74:75], v[42:43], v[46:47]
    v_pk_add_f32 v[78:79], v[50:51], v[54:55]
    v_pk_add_f32 v[72:73], v[72:73], v[76:77]
    v_pk_add_f32 v[74:75], v[74:75], v[78:79]
    v_lshlrev_b32 v24, 16, v24
    v_permlane16_swap_b32 v72, v73
    v_permlane16_swap_b32 v74, v75
    v_add_f32 v72, v72, v73
    v_add_f32 v74, v74, v75
    s_nop 1
    v_permlane32_swap_b32 v72, v74
    v_add_f32 v72, v72, v74
    s_nop 1
    v_add_f32_dpp v72, v72, v72 row_ror:8 row_mask:0xf bank_mask:0xf
    v_cvt_pk_bf16_f32 v72, 0, v72
    v_add_f32 v73, v72, v24
    v_add_f32 v72, v72, v24
    s_nop 1
    v_permlane16_swap_b32 v72, v73
    v_cvt_pk_bf16_f32 v72, v72, v73
    v_min_u32 v73, -2, v72
    v_min_u32 v72, -2, v72
    s_nop 1
    v_permlane32_swap_b32 v72, v73
    s_nop 1
    v_mov_b32_dpp v74, v72 row_shl:1 row_mask:0xf bank_mask:0xf
    v_mov_b32_dpp v75, v73 row_shl:1 row_mask:0xf bank_mask:0xf
    buffer_store_dwordx4 v[72:75], v61, s[52:55], 0 offen sc1
    s_branch L_fin
L_mlp:
    s_cmp_eq_u32 s66, 1
    s_cbranch_scc0 L_frag2
L_role1:
    buffer_load_dwordx4 v[208:211], v62, s[56:59], 0 offen
    buffer_load_dwordx4 v[212:215], v62, s[56:59], s10 offen
    buffer_load_dwordx4 v[216:219], v62, s[56:59], s11 offen
    buffer_load_dwordx4 v[220:223], v62, s[56:59], s12 offen
    buffer_load_dwordx4 v[224:227], v62, s[56:59], s13 offen
    v_mov_b32 v36, 0x3f803f80
    v_mov_b32 v37, 0x3acccccd
    s_and_b32 s8, s3, 7
    s_lshl_b32 s8, s8, 3
    s_lshl_b64 exec, 1, s8
    buffer_load_dword v4, v112, s[52:55], 0 offen sc1
    s_mov_b64 exec, -1
    s_waitcnt vmcnt(5)
    ds_write_b128 v105, v[208:211] offset:0
    s_waitcnt vmcnt(4)
    ds_write_b128 v105, v[212:215] offset:1024
    s_waitcnt vmcnt(3)
    ds_write_b128 v105, v[216:219] offset:2048
    s_waitcnt vmcnt(2)
    ds_write_b128 v105, v[220:223] offset:3072
    s_waitcnt vmcnt(1)
    ds_write_b128 v105, v[224:227] offset:4096
    s_cmp_lt_u32 s30, 2
    s_waitcnt lgkmcnt(0)
    s_barrier
    s_cbranch_scc0 L_frag_done
    v_mov_b32 v12, 0
    v_mov_b32 v13, 0
    v_mov_b32 v14, 0
    v_mov_b32 v15, 0
    ds_read_b64_tr_b16 v[128:129], v119 offset:0
    ds_read_b64_tr_b16 v[130:131], v119 offset:64
    ds_read_b64_tr_b16 v[132:133], v119 offset:1024
    ds_read_b64_tr_b16 v[134:135], v119 offset:1088
    ds_read_b64_tr_b16 v[136:137], v119 offset:2048
    ds_read_b64_tr_b16 v[138:139], v119 offset:2112
    ds_read_b64_tr_b16 v[140:141], v119 offset:3072
    ds_read_b64_tr_b16 v[142:143], v119 offset:3136
    ds_read_b64_tr_b16 v[144:145], v119 offset:4096
    ds_read_b64_tr_b16 v[146:147], v119 offset:4160
    ds_read_b64_tr_b16 v[148:149], v119 offset:5120
    ds_read_b64_tr_b16 v[150:151], v119 offset:5184
    ds_read_b64_tr_b16 v[152:153], v119 offset:6144
    ds_read_b64_tr_b16 v[154:155], v119 offset:6208
    ds_read_b64_tr_b16 v[156:157], v119 offset:7168
    ds_read_b64_tr_b16 v[158:159], v119 offset:7232
    ds_read_b64_tr_b16 v[160:161], v119 offset:8192
    ds_read_b64_tr_b16 v[162:163], v119 offset:8256
    ds_read_b64_tr_b16 v[164:165], v119 offset:9216
    ds_read_b64_tr_b16 v[166:167], v119 offset:9280
    ds_read_b64_tr_b16 v[168:169], v119 offset:10240
    ds_read_b64_tr_b16 v[170:171], v119 offset:10304
    ds_read_b64_tr_b16 v[172:173], v119 offset:11264
    ds_read_b64_tr_b16 v[174:175], v119 offset:11328
    ds_read_b64_tr_b16 v[176:177], v119 offset:12288
    ds_read_b64_tr_b16 v[178:179], v119 offset:12352
    ds_read_b64_tr_b16 v[180:181], v119 offset:13312
    ds_read_b64_tr_b16 v[182:183], v119 offset:13376
    ds_read_b64_tr_b16 v[184:185], v119 offset:14336
    ds_read_b64_tr_b16 v[186:187], v119 offset:14400
    ds_read_b64_tr_b16 v[188:189], v119 offset:15360
    ds_read_b64_tr_b16 v[190:191], v119 offset:15424
    ds_read_b64_tr_b16 v[192:193], v119 offset:16384
    ds_read_b64_tr_b16 v[194:195], v119 offset:16448
    ds_read_b64_tr_b16 v[196:197], v119 offset:17408
    ds_read_b64_tr_b16 v[198:199], v119 offset:17472
    ds_read_b64_tr_b16 v[200:201], v119 offset:18432
    ds_read_b64_tr_b16 v[202:203], v119 offset:18496
    ds_read_b64_tr_b16 v[204:205], v119 offset:19456
    ds_read_b64_tr_b16 v[206:207], v119 offset:19520
    s_branch L_frag_done
L_frag2:
    v_lshrrev_b32 v24, 3, v122
    v_lshlrev_b32 v24, 7, v24
    v_and_b32 v26, 3, v122
    v_lshl_add_u32 v24, v26, 5, v24
    v_bfe_u32 v26, v122, 2, 1
    v_lshl_add_u32 v24, v26, 3, v24
    v_lshrrev_b32 v25, 5, v122
    v_lshlrev_b32 v25, 7, v25
    v_lshrrev_b32 v26, 1, v124
    v_lshl_add_u32 v25, v26, 4, v25
    v_and_b32 v26, 1, v123
    v_lshl_add_u32 v25, v26, 3, v25
    v_and_b32 v26, 1, v122
    v_lshl_add_u32 v25, v26, 2, v25
    global_load_dwordx2 v[252:253], v24, s[16:17]
    global_load_dwordx2 v[254:255], v24, s[16:17] offset:16
    global_load_dword v101, v25, s[16:17] offset:1024
    v_mov_b32 v220, 0
    v_mov_b32 v221, 0
    v_mov_b32 v222, 0
    v_mov_b32 v223, 0
    s_cmp_lt_u32 s30, 3
    s_cbranch_scc0 L_t2_3
    buffer_load_dwordx4 v[220:223], v62, s[56:59], s12 offen
L_t2_3:
    buffer_load_dwordx4 v[208:211], v62, s[56:59], 0 offen
    buffer_load_dwordx4 v[212:215], v62, s[56:59], s10 offen
    buffer_load_dwordx4 v[216:219], v62, s[56:59], s11 offen
    v_mov_b32 v36, 0x3f803f80
    v_mov_b32 v37, 0x3acccccd
    s_and_b32 s8, s3, 7
    s_lshl_b32 s8, s8, 3
    s_lshl_b64 exec, 1, s8
    buffer_load_dword v4, v112, s[52:55], 0 offen sc1
    s_mov_b64 exec, -1
    s_lshl_b32 s64, s30, 2
    v_mov_b32 v29, s64
    s_mov_b32 s10, 0x4000
    s_mov_b32 s11, 0x8000
    s_mov_b32 s12, 0xc000
    v_lshrrev_b32 v26, 3, v122
    v_lshlrev_b32 v26, 2, v26
    v_add_u32 v27, 640, v121
    v_mul_u32_u24 v6, 70, v122
    v_and_b32 v7, 0xc0, v6
    v_add_lshl_u32 v6, v6, v7, 7
    v_add_u32 v6, s15, v6
    v_add_u32 v19, s15, v1
    v_mov_b32 v52, 0
    v_mov_b32 v53, 0
    v_mov_b32 v54, 0
    v_mov_b32 v55, 0
    s_waitcnt vmcnt(3)
    ds_write_b128 v105, v[208:211] offset:0
    s_waitcnt vmcnt(2)
    ds_write_b128 v105, v[212:215] offset:1024
    s_waitcnt vmcnt(1)
    ds_write_b128 v105, v[216:219] offset:2048
    ds_write_b128 v105, v[220:223] offset:3072
    ds_read_b64_tr_b16 v[232:233], v119 offset:0
    ds_read_b64_tr_b16 v[234:235], v119 offset:64
    ds_read_b64_tr_b16 v[236:237], v119 offset:1024
    ds_read_b64_tr_b16 v[238:239], v119 offset:1088
    ds_read_b64_tr_b16 v[240:241], v119 offset:2048
    ds_read_b64_tr_b16 v[242:243], v119 offset:2112
    ds_read_b64_tr_b16 v[244:245], v119 offset:3072
    ds_read_b64_tr_b16 v[246:247], v119 offset:3136
L_frag_done:
    s_lshl_b64 exec, 1, s8
    s_branch L_hp_first
L_hp_poll:
    buffer_load_dword v4, v112, s[52:55], 0 offen sc1
L_hp_first:
    s_waitcnt vmcnt(0)
    v_cmp_ne_u32 vcc, -1, v4
    s_cbranch_vccz L_hp_again
    s_mov_b64 exec, -1
L_h_poll:
    buffer_load_dwordx4 v[96:99], v112, s[52:55], 0 offen sc1
    buffer_load_dword v100, v113, s[52:55], 0 offen offset:1024 sc1
L_h_wait:
    s_waitcnt vmcnt(0)
    v_max3_u32 v28, v96, v97, v98
    v_max3_u32 v28, v28, v99, v100
    v_cmp_eq_u32 vcc, -1, v28
    s_cbranch_vccnz L_h_again
    v_dot2_f32_bf16 v35, v96, v96, 0
    v_dot2_f32_bf16 v34, v96, v36, 0
    v_dot2_f32_bf16 v35, v97, v97, v35
    v_dot2_f32_bf16 v34, v97, v36, v34
    v_dot2_f32_bf16 v35, v98, v98, v35
    v_dot2_f32_bf16 v34, v98, v36, v34
    v_dot2_f32_bf16 v35, v99, v99, v35
    v_dot2_f32_bf16 v34, v99, v36, v34
    v_dot2_f32_bf16 v35, v100, v100, v35
    v_dot2_f32_bf16 v34, v100, v36, v34
    v_lshlrev_b32 v102, 16, v96
    v_and_b32 v103, 0xffff0000, v96
    v_lshlrev_b32 v104, 16, v97
    v_add_f32_dpp v35, v35, v35 row_ror:8 row_mask:0xf bank_mask:0xf
    v_add_f32_dpp v34, v34, v34 row_ror:8 row_mask:0xf bank_mask:0xf
    v_and_b32 v105, 0xffff0000, v97
    v_add_f32_dpp v35, v35, v35 row_ror:4 row_mask:0xf bank_mask:0xf
    v_add_f32_dpp v34, v34, v34 row_ror:4 row_mask:0xf bank_mask:0xf
    v_lshlrev_b32 v106, 16, v98
    v_add_f32_dpp v35, v35, v35 row_ror:2 row_mask:0xf bank_mask:0xf
    v_add_f32_dpp v34, v34, v34 row_ror:2 row_mask:0xf bank_mask:0xf
    v_and_b32 v107, 0xffff0000, v98
    v_add_f32_dpp v35, v35, v35 row_ror:1 row_mask:0xf bank_mask:0xf
    v_add_f32_dpp v34, v34, v34 row_ror:1 row_mask:0xf bank_mask:0xf
    v_lshlrev_b32 v108, 16, v99
    v_add_f32_dpp v35, v35, v35 row_bcast:15 row_mask:0xa bank_mask:0xf
    v_add_f32_dpp v34, v34, v34 row_bcast:15 row_mask:0xa bank_mask:0xf
    v_and_b32 v109, 0xffff0000, v99
    v_add_f32_dpp v35, v35, v35 row_bcast:31 row_mask:0xc bank_mask:0xf
    v_add_f32_dpp v34, v34, v34 row_bcast:31 row_mask:0xc bank_mask:0xf
    v_lshlrev_b32 v110, 16, v100
    v_readlane_b32 s65, v35, 63
    v_readlane_b32 s64, v34, 63
    v_and_b32 v111, 0xffff0000, v100
    v_mul_f32 v32, s65, v37
    v_mul_f32 v30, s64, v37
    v_fma_f32 v32, -v30, v30, v32
    v_cvt_pk_bf16_f32 v30, 0, v30
    v_max_f32 v32, 0, v32
    v_cvt_pk_bf16_f32 v32, 0, v32
    v_pk_add_f32 v[102:103], v[102:103], v[30:31] op_sel_hi:[1,0] neg_lo:[0,1] neg_hi:[0,1]
    v_pk_add_f32 v[104:105], v[104:105], v[30:31] op_sel_hi:[1,0] neg_lo:[0,1] neg_hi:[0,1]
    v_add_f32 v32, 0x3727c5ac, v32
    v_pk_add_f32 v[106:107], v[106:107], v[30:31] op_sel_hi:[1,0] neg_lo:[0,1] neg_hi:[0,1]
    v_pk_add_f32 v[108:109], v[108:109], v[30:31] op_sel_hi:[1,0] neg_lo:[0,1] neg_hi:[0,1]
    v_cvt_pk_bf16_f32 v32, 0, v32
    v_pk_add_f32 v[110:111], v[110:111], v[30:31] op_sel_hi:[1,0] neg_lo:[0,1] neg_hi:[0,1]
    v_cvt_pk_bf16_f32 v102, 0, v102
    v_sqrt_f32 v32, v32
    v_cvt_pk_bf16_f32 v103, 0, v103
    v_cvt_pk_bf16_f32 v104, 0, v104
    v_cvt_pk_bf16_f32 v32, 0, v32
    v_cvt_pk_bf16_f32 v105, 0, v105
    v_cvt_pk_bf16_f32 v106, 0, v106
    v_rcp_f32 v32, v32
    v_cvt_pk_bf16_f32 v107, 0, v107
    v_cvt_pk_bf16_f32 v108, 0, v108
    v_cvt_pk_bf16_f32 v109, 0, v109
    v_cvt_pk_bf16_f32 v110, 0, v110
    v_cvt_pk_bf16_f32 v111, 0, v111
    v_pk_mul_f32 v[102:103], v[102:103], v[32:33] op_sel_hi:[1,0]
    v_pk_mul_f32 v[104:105], v[104:105], v[32:33] op_sel_hi:[1,0]
    v_pk_mul_f32 v[106:107], v[106:107], v[32:33] op_sel_hi:[1,0]
    v_pk_mul_f32 v[108:109], v[108:109], v[32:33] op_sel_hi:[1,0]
    v_pk_mul_f32 v[110:111], v[110:111], v[32:33] op_sel_hi:[1,0]
    v_cvt_pk_bf16_f32 v72, v102, v103
    v_cvt_pk_bf16_f32 v73, v104, v105
    v_cvt_pk_bf16_f32 v74, v106, v107
    v_cvt_pk_bf16_f32 v75, v108, v109
    v_cvt_pk_bf16_f32 v76, v110, v111
    ds_write_b128 v114, v[72:75]
    ds_write_b32 v118, v76 offset:1024
    s_cmp_eq_u32 s66, 1
    s_cbranch_scc0 L_stage2
    s_cmp_lt_u32 s30, 2
    s_waitcnt lgkmcnt(0)
    s_barrier
    s_cbranch_scc0 L_fin
    ds_read_b128 v[40:43], v120 offset:8192
    ds_read_b128 v[44:47], v120 offset:8320
    ds_read_b128 v[48:51], v120 offset:8448
    ds_read_b128 v[52:55], v120 offset:8576
    ds_read_b128 v[56:59], v120 offset:8704
    ds_read_b128 v[232:235], v120 offset:8832
    ds_read_b128 v[236:239], v120 offset:8960
    ds_read_b128 v[240:243], v120 offset:9088
    ds_read_b128 v[244:247], v120 offset:9216
    ds_read_b128 v[248:251], v120 offset:9344
    s_waitcnt lgkmcnt(9)
    v_smfmac_f32_16x16x64_bf16 v[12:15], v[40:43], v[128:135], v121
    s_waitcnt lgkmcnt(8)
    v_smfmac_f32_16x16x64_bf16 v[12:15], v[44:47], v[136:143], v121
    s_waitcnt lgkmcnt(7)
    v_smfmac_f32_16x16x64_bf16 v[12:15], v[48:51], v[144:151], v121
    s_waitcnt lgkmcnt(6)
    v_smfmac_f32_16x16x64_bf16 v[12:15], v[52:55], v[152:159], v121
    s_waitcnt lgkmcnt(5)
    v_smfmac_f32_16x16x64_bf16 v[12:15], v[56:59], v[160:167], v121
    s_waitcnt lgkmcnt(4)
    v_smfmac_f32_16x16x64_bf16 v[12:15], v[232:235], v[168:175], v121
    s_waitcnt lgkmcnt(3)
    v_smfmac_f32_16x16x64_bf16 v[12:15], v[236:239], v[176:183], v121
    s_waitcnt lgkmcnt(2)
    v_smfmac_f32_16x16x64_bf16 v[12:15], v[240:243], v[184:191], v121
    s_waitcnt lgkmcnt(1)
    v_smfmac_f32_16x16x64_bf16 v[12:15], v[244:247], v[192:199], v121
    s_waitcnt lgkmcnt(0)
    v_smfmac_f32_16x16x64_bf16 v[12:15], v[248:251], v[200:207], v121
    s_xor_b32 s10, s15, 0x2000
    s_nop 6
    v_permlane32_swap_b32 v12, v14
    v_permlane32_swap_b32 v13, v15
    v_add_f32 v40, v12, v14
    v_add_f32 v42, v13, v15
    v_add_f32 v41, v13, v15
    v_mov_b32_dpp v41, v40 row_ror:8 row_mask:0xf bank_mask:0x3
    v_mov_b32_dpp v40, v42 row_ror:8 row_mask:0xf bank_mask:0xc
    v_cvt_pk_bf16_f32 v40, 0, v40
    v_mul_f32 v42, 0xbfb8aa3b, v40
    v_exp_f32 v42, v42
    v_cvt_pk_bf16_f32 v41, 0, v41
    v_add_f32 v42, 1.0, v42
    v_rcp_f32 v42, v42
    s_nop 0
    v_mul_f32 v40, v40, v42
    v_cvt_pk_bf16_f32 v40, 0, v40
    v_mul_f32 v40, v40, v41
    s_nop 1
    v_mov_b32_dpp v41, v40 row_shl:1 row_mask:0xf bank_mask:0xf
    v_cvt_pk_bf16_f32 v40, v40, v41
    v_min_u32 v40, -2, v40
    s_nop 1
    v_mov_b32_dpp v41, v40 row_shl:2 row_mask:0xf bank_mask:0xf
    v_mov_b32_dpp v42, v40 row_shl:4 row_mask:0xf bank_mask:0xf
    v_mov_b32_dpp v43, v40 row_shl:6 row_mask:0xf bank_mask:0xf
    buffer_store_dwordx4 v[40:43], v61, s[52:55], s10 offen sc1
    buffer_store_dwordx4 v[40:43], v61, s[52:55], s15 offen sc1
    s_branch L_fin
L_stage2:
    s_cmp_eq_u32 s30, 0
    s_cbranch_scc0 L_ap_skip
    s_mov_b64 exec, 7
L_ap_poll:
    buffer_load_dword v5, v6, s[60:63], 0 offen sc1
L_ap_first:
    s_waitcnt vmcnt(0)
    v_cmp_ne_u32 vcc, -1, v5
    s_cbranch_vccz L_ap_again
    s_mov_b64 exec, -1
L_ap_skip:
    s_cmp_lt_u32 s30, 3
    s_waitcnt lgkmcnt(0)
    s_barrier
    s_cbranch_scc0 L_act_n3
    buffer_load_dwordx4 v[52:55], v19, s[60:63], s12 offen sc1
L_act_n3:
    buffer_load_dwordx4 v[40:43], v19, s[60:63], 0 offen sc1
    buffer_load_dwordx4 v[44:47], v19, s[60:63], s10 offen sc1
    buffer_load_dwordx4 v[48:51], v19, s[60:63], s11 offen sc1
    ds_write_b64 v114, v[96:97] offset:10752
    ds_write_b64 v114, v[98:99] offset:10760
    ds_write_b32 v118, v100 offset:11776
    v_dot2_f32_bf16 v28, v72, v252, 0
    v_dot2_f32_bf16 v28, v73, v253, v28
    v_dot2_f32_bf16 v28, v74, v254, v28
    v_dot2_f32_bf16 v28, v75, v255, v28
    v_dot2_f32_bf16 v28, v76, v101, v28
    s_nop 2
    v_add_f32_dpp v28, v28, v28 row_ror:8 row_mask:0xf bank_mask:0xf
    s_nop 1
    v_add_f32_dpp v28, v28, v28 row_ror:4 row_mask:0xf bank_mask:0xf
    s_nop 1
    v_add_f32_dpp v28, v28, v28 row_ror:2 row_mask:0xf bank_mask:0xf
    s_nop 1
    v_add_f32_dpp v28, v28, v28 row_ror:1 row_mask:0xf bank_mask:0xf
    s_nop 1
    v_add_f32_dpp v28, v28, v28 row_bcast:15 row_mask:0xa bank_mask:0xf
    s_nop 1
    v_add_f32_dpp v28, v28, v28 row_bcast:31 row_mask:0xc bank_mask:0xf
    v_cvt_pk_bf16_f32 v28, 0, v28
    v_mul_f32 v28, 0xbfb8aa3b, v28
    v_exp_f32 v28, v28
    s_nop 0
    v_add_f32 v28, 1.0, v28
    v_rcp_f32 v28, v28
    s_nop 0
    v_cvt_pk_bf16_f32 v28, 0, v28
    s_mov_b32 exec_lo, 0
    s_mov_b32 exec_hi, 0x80000000
    ds_write_b32 v29, v28 offset:4416
    s_mov_b64 exec, -1
L_act_chk:
    s_waitcnt vmcnt(2)
    v_mfma_f32_16x16x32_bf16 v[12:15], v[52:55], v[244:247], 0
    v_max3_u32 v25, v52, v53, v52
    v_max3_u32 v25, v54, v55, v25
    v_mfma_f32_16x16x32_bf16 v[12:15], v[40:43], v[232:235], v[12:15]
    v_max3_u32 v25, v40, v41, v25
    v_max3_u32 v25, v42, v43, v25
    s_waitcnt vmcnt(1)
    v_mfma_f32_16x16x32_bf16 v[12:15], v[44:47], v[236:239], v[12:15]
    v_max3_u32 v25, v44, v45, v25
    v_max3_u32 v25, v46, v47, v25
    s_waitcnt vmcnt(0)
    v_mfma_f32_16x16x32_bf16 v[12:15], v[48:51], v[240:243], v[12:15]
    v_max3_u32 v25, v48, v49, v25
    v_max3_u32 v25, v50, v51, v25
    v_cmp_eq_u32 vcc, -1, v25
    s_cbranch_vccnz L_act_again
    s_cmp_eq_u32 s30, 0
    s_nop 2
    ds_write_b128 v1, v[12:15] offset:32768
    s_waitcnt lgkmcnt(0)
    s_barrier
    s_cbranch_scc0 L_fin
    ds_read2st64_b32 v[80:81], v121 offset0:0 offset1:4
    ds_read2st64_b32 v[82:83], v27 offset0:0 offset1:4
    ds_read2st64_b32 v[84:85], v121 offset0:8 offset1:12
    ds_read2st64_b32 v[86:87], v27 offset0:8 offset1:12
    ds_read2st64_b32 v[88:89], v121 offset0:16 offset1:20
    ds_read2st64_b32 v[90:91], v27 offset0:16 offset1:20
    ds_read2st64_b32 v[92:93], v121 offset0:24 offset1:28
    ds_read2st64_b32 v[94:95], v27 offset0:24 offset1:28
    ds_read_b32 v34, v26 offset:4416
    ds_read_u16 v32, v120 offset:8192
    ds_read_u16 v33, v120 offset:18944
    s_waitcnt lgkmcnt(3)
    v_pk_add_f32 v[72:73], v[80:81], v[84:85]
    v_pk_add_f32 v[76:77], v[88:89], v[92:93]
    v_pk_add_f32 v[74:75], v[82:83], v[86:87]
    v_pk_add_f32 v[78:79], v[90:91], v[94:95]
    v_pk_add_f32 v[72:73], v[72:73], v[76:77]
    v_pk_add_f32 v[74:75], v[74:75], v[78:79]
    v_pk_add_f32 v[72:73], v[72:73], v[74:75]
    s_waitcnt lgkmcnt(0)
    v_lshlrev_b32 v32, 16, v32
    v_lshlrev_b32 v33, 16, v33
    v_add_f32 v72, v72, v73
    v_cvt_pk_bf16_f32 v72, 0, v72
    v_mul_f32 v72, v72, v34
    v_cvt_pk_bf16_f32 v72, 0, v72
    v_add_f32 v72, v72, v32
    v_cvt_pk_bf16_f32 v72, 0, v72
    v_add_f32 v72, v72, v33
    v_cvt_pk_bf16_f32 v72, v72, v72
    global_store_short v127, v72, s[24:25]
    s_cmp_eq_u32 s67, 0
    s_cbranch_scc0 L_fin
    s_mov_b64 exec, 1
    v_mov_b32 v22, s0
    buffer_store_dword v22, v126, s[52:55], 0 offen offset:3072
L_fin:
L_end:
    s_endpgm
L_hp_again:
    s_sub_u32 s9, s9, 1
    s_cbranch_scc0 L_hp_poll
    s_branch L_fin
L_h_again:
    s_sub_u32 s9, s9, 1
    s_cbranch_scc0 L_h_poll
    s_branch L_fin
L_ap_again:
    s_sub_u32 s9, s9, 1
    s_cbranch_scc0 L_ap_poll
    s_branch L_fin
L_op2:
    s_nop 0
    v_mov_b64_dpp v[16:17], v[20:21] row_newbcast:0 row_mask:0xf bank_mask:0xf
    v_mov_b64_dpp v[18:19], v[20:21] row_newbcast:1 row_mask:0xf bank_mask:0xf
    v_mov_b64_dpp v[36:37], v[20:21] row_newbcast:2 row_mask:0xf bank_mask:0xf
    v_mov_b64_dpp v[38:39], v[20:21] row_newbcast:3 row_mask:0xf bank_mask:0xf
    v_smfmac_f32_16x16x64_bf16 v[40:43], v[16:19], v[128:135], v115
    v_mov_b64_dpp v[8:9], v[20:21] row_newbcast:4 row_mask:0xf bank_mask:0xf
    v_smfmac_f32_16x16x64_bf16 v[44:47], v[16:19], v[192:199], v115
    v_mov_b64_dpp v[10:11], v[20:21] row_newbcast:5 row_mask:0xf bank_mask:0xf
    v_smfmac_f32_16x16x64_bf16 v[40:43], v[36:39], v[136:143], v115
    v_mov_b64_dpp v[16:17], v[20:21] row_newbcast:6 row_mask:0xf bank_mask:0xf
    v_smfmac_f32_16x16x64_bf16 v[44:47], v[36:39], v[200:207], v115
    v_mov_b64_dpp v[18:19], v[20:21] row_newbcast:7 row_mask:0xf bank_mask:0xf
    v_smfmac_f32_16x16x64_bf16 v[40:43], v[8:11], v[144:151], v115
    v_mov_b64_dpp v[36:37], v[20:21] row_newbcast:8 row_mask:0xf bank_mask:0xf
    v_smfmac_f32_16x16x64_bf16 v[44:47], v[8:11], v[208:215], v115
    v_mov_b64_dpp v[38:39], v[20:21] row_newbcast:9 row_mask:0xf bank_mask:0xf
    v_smfmac_f32_16x16x64_bf16 v[40:43], v[16:19], v[152:159], v115
    v_mov_b64_dpp v[8:9], v[20:21] row_newbcast:10 row_mask:0xf bank_mask:0xf
    v_smfmac_f32_16x16x64_bf16 v[44:47], v[16:19], v[216:223], v115
    v_mov_b64_dpp v[10:11], v[20:21] row_newbcast:11 row_mask:0xf bank_mask:0xf
    v_smfmac_f32_16x16x64_bf16 v[40:43], v[36:39], v[160:167], v115
    v_mov_b64_dpp v[16:17], v[20:21] row_newbcast:12 row_mask:0xf bank_mask:0xf
    v_smfmac_f32_16x16x64_bf16 v[44:47], v[36:39], v[224:231], v115
    v_mov_b64_dpp v[18:19], v[20:21] row_newbcast:13 row_mask:0xf bank_mask:0xf
    v_smfmac_f32_16x16x64_bf16 v[40:43], v[8:11], v[168:175], v115
    v_mov_b64_dpp v[36:37], v[20:21] row_newbcast:14 row_mask:0xf bank_mask:0xf
    v_smfmac_f32_16x16x64_bf16 v[44:47], v[8:11], v[232:239], v115
    v_mov_b64_dpp v[38:39], v[20:21] row_newbcast:15 row_mask:0xf bank_mask:0xf
    v_smfmac_f32_16x16x64_bf16 v[40:43], v[16:19], v[176:183], v115
    v_smfmac_f32_16x16x64_bf16 v[44:47], v[16:19], v[240:247], v115
    v_smfmac_f32_16x16x64_bf16 v[40:43], v[36:39], v[184:191], v115
    v_smfmac_f32_16x16x64_bf16 v[44:47], v[36:39], v[248:255], v115
    s_mov_b64 exec, 0xffff
    s_nop 5
    v_and_or_b32 v64, v40, v117, s14
    v_and_or_b32 v65, v41, v117, s14
    v_and_or_b32 v66, v42, v117, s14
    v_and_or_b32 v67, v43, v117, s14
    buffer_store_dwordx4 v[64:67], v60, s[52:55], 0 offen offset:0 sc1
    v_and_or_b32 v68, v44, v117, s14
    v_and_or_b32 v69, v45, v117, s14
    v_and_or_b32 v70, v46, v117, s14
    v_and_or_b32 v71, v47, v117, s14
    buffer_store_dwordx4 v[68:71], v60, s[52:55], 0 offen offset:2048 sc1
    s_branch L_pub_done
L_act_again:
    v_max3_u32 v25, v52, v53, v54
    v_max_u32 v25, v25, v55
    v_cmp_eq_u32 s[38:39], -1, v25
    s_nop 0
    s_or_b64 exec, s[38:39], 1
    buffer_load_dwordx4 v[52:55], v19, s[60:63], s12 offen sc1
    s_mov_b64 exec, -1
    v_max3_u32 v25, v40, v41, v42
    v_max_u32 v25, v25, v43
    v_cmp_eq_u32 s[32:33], -1, v25
    s_nop 0
    s_or_b64 exec, s[32:33], 1
    buffer_load_dwordx4 v[40:43], v19, s[60:63], 0 offen sc1
    s_mov_b64 exec, -1
    v_max3_u32 v25, v44, v45, v46
    v_max_u32 v25, v25, v47
    v_cmp_eq_u32 s[34:35], -1, v25
    s_nop 0
    s_or_b64 exec, s[34:35], 1
    buffer_load_dwordx4 v[44:47], v19, s[60:63], s10 offen sc1
    s_mov_b64 exec, -1
    v_max3_u32 v25, v48, v49, v50
    v_max_u32 v25, v25, v51
    v_cmp_eq_u32 s[36:37], -1, v25
    s_nop 0
    s_or_b64 exec, s[36:37], 1
    buffer_load_dwordx4 v[48:51], v19, s[60:63], s11 offen sc1
    s_mov_b64 exec, -1
    s_sub_u32 s9, s9, 1
    s_cbranch_scc0 L_act_chk
    s_branch L_fin
L_red_early:
    global_load_ushort v24, v112, s[4:5]
    buffer_load_dwordx4 v[80:83], v105, s[52:55], 0 offen sc1
    buffer_load_dwordx4 v[84:87], v105, s[52:55], s10 offen sc1
    buffer_load_dwordx4 v[88:91], v105, s[52:55], s11 offen sc1
    buffer_load_dwordx4 v[92:95], v105, s[52:55], s12 offen sc1
    s_branch L_red_back
L_rdy_spin:
    global_load_dword v125, v126, s[26:27] sc1
    s_waitcnt vmcnt(0)
    v_readfirstlane_b32 s64, v125
    s_bitcmp1_b32 s64, 5
    s_cbranch_scc1 L_ready
    s_sub_u32 s9, s9, 1
    s_cbranch_scc0 L_rdy_spin
    s_branch L_fin
L_bq:
    s_waitcnt lgkmcnt(0)
    s_barrier
    ds_read_u16 v20, v125 offset:8192
    ds_read_u16 v21, v125 offset:9216
    s_mov_b32 s64, 0
    buffer_load_dwordx4 v[64:67], v2, s[40:43], s64 offen sc1
    s_waitcnt vmcnt(2)
    s_mov_b32 s64, 262144
    buffer_load_dwordx4 v[68:71], v2, s[40:43], s64 offen sc1
    s_waitcnt vmcnt(2)
    s_mov_b32 s64, 524288
    buffer_load_dwordx4 v[72:75], v2, s[40:43], s64 offen sc1
    s_waitcnt lgkmcnt(0)
    v_lshl_or_b32 v20, v20, 16, v20
    v_lshl_or_b32 v21, v21, 16, v21
    s_nop 0
    v_and_b32_dpp v8, v20, v4 row_newbcast:0 row_mask:0xf bank_mask:0xf
    v_and_b32_dpp v9, v20, v5 row_newbcast:0 row_mask:0xf bank_mask:0xf
    v_and_b32_dpp v10, v20, v6 row_newbcast:0 row_mask:0xf bank_mask:0xf
    v_and_b32_dpp v11, v20, v7 row_newbcast:0 row_mask:0xf bank_mask:0xf
    s_waitcnt vmcnt(2)
    s_nop 0
    v_mfma_f32_16x16x32_bf16 v[12:15], v[8:11], v[64:67], v[12:15]
    s_mov_b32 s64, 786432
    buffer_load_dwordx4 v[76:79], v2, s[40:43], s64 offen sc1
    v_and_b32_dpp v8, v20, v4 row_newbcast:1 row_mask:0xf bank_mask:0xf
    v_and_b32_dpp v9, v20, v5 row_newbcast:1 row_mask:0xf bank_mask:0xf
    v_and_b32_dpp v10, v20, v6 row_newbcast:1 row_mask:0xf bank_mask:0xf
    v_and_b32_dpp v11, v20, v7 row_newbcast:1 row_mask:0xf bank_mask:0xf
    s_waitcnt vmcnt(2)
    s_nop 0
    v_mfma_f32_16x16x32_bf16 v[12:15], v[8:11], v[68:71], v[12:15]
    s_mov_b32 s64, 1048576
    buffer_load_dwordx4 v[80:83], v2, s[40:43], s64 offen sc1
    v_and_b32_dpp v8, v20, v4 row_newbcast:2 row_mask:0xf bank_mask:0xf
    v_and_b32_dpp v9, v20, v5 row_newbcast:2 row_mask:0xf bank_mask:0xf
    v_and_b32_dpp v10, v20, v6 row_newbcast:2 row_mask:0xf bank_mask:0xf
    v_and_b32_dpp v11, v20, v7 row_newbcast:2 row_mask:0xf bank_mask:0xf
    s_waitcnt vmcnt(2)
    s_nop 0
    v_mfma_f32_16x16x32_bf16 v[12:15], v[8:11], v[72:75], v[12:15]
    s_mov_b32 s64, 1310720
    buffer_load_dwordx4 v[84:87], v2, s[40:43], s64 offen sc1
    v_and_b32_dpp v8, v20, v4 row_newbcast:3 row_mask:0xf bank_mask:0xf
    v_and_b32_dpp v9, v20, v5 row_newbcast:3 row_mask:0xf bank_mask:0xf
    v_and_b32_dpp v10, v20, v6 row_newbcast:3 row_mask:0xf bank_mask:0xf
    v_and_b32_dpp v11, v20, v7 row_newbcast:3 row_mask:0xf bank_mask:0xf
    s_waitcnt vmcnt(2)
    s_nop 0
    v_mfma_f32_16x16x32_bf16 v[12:15], v[8:11], v[76:79], v[12:15]
    s_mov_b32 s64, 1572864
    buffer_load_dwordx4 v[88:91], v2, s[40:43], s64 offen sc1
    v_and_b32_dpp v8, v20, v4 row_newbcast:4 row_mask:0xf bank_mask:0xf
    v_and_b32_dpp v9, v20, v5 row_newbcast:4 row_mask:0xf bank_mask:0xf
    v_and_b32_dpp v10, v20, v6 row_newbcast:4 row_mask:0xf bank_mask:0xf
    v_and_b32_dpp v11, v20, v7 row_newbcast:4 row_mask:0xf bank_mask:0xf
    s_waitcnt vmcnt(2)
    s_nop 0
    v_mfma_f32_16x16x32_bf16 v[12:15], v[8:11], v[80:83], v[12:15]
    s_mov_b32 s64, 1835008
    buffer_load_dwordx4 v[92:95], v2, s[40:43], s64 offen sc1
    v_and_b32_dpp v8, v20, v4 row_newbcast:5 row_mask:0xf bank_mask:0xf
    v_and_b32_dpp v9, v20, v5 row_newbcast:5 row_mask:0xf bank_mask:0xf
    v_and_b32_dpp v10, v20, v6 row_newbcast:5 row_mask:0xf bank_mask:0xf
    v_and_b32_dpp v11, v20, v7 row_newbcast:5 row_mask:0xf bank_mask:0xf
    s_waitcnt vmcnt(2)
    s_nop 0
    v_mfma_f32_16x16x32_bf16 v[12:15], v[8:11], v[84:87], v[12:15]
    s_mov_b32 s64, 2097152
    buffer_load_dwordx4 v[64:67], v2, s[40:43], s64 offen sc1
    v_and_b32_dpp v8, v20, v4 row_newbcast:6 row_mask:0xf bank_mask:0xf
    v_and_b32_dpp v9, v20, v5 row_newbcast:6 row_mask:0xf bank_mask:0xf
    v_and_b32_dpp v10, v20, v6 row_newbcast:6 row_mask:0xf bank_mask:0xf
    v_and_b32_dpp v11, v20, v7 row_newbcast:6 row_mask:0xf bank_mask:0xf
    s_waitcnt vmcnt(2)
    s_nop 0
    v_mfma_f32_16x16x32_bf16 v[12:15], v[8:11], v[88:91], v[12:15]
    s_mov_b32 s64, 2359296
    buffer_load_dwordx4 v[68:71], v2, s[40:43], s64 offen sc1
    v_and_b32_dpp v8, v20, v4 row_newbcast:7 row_mask:0xf bank_mask:0xf
    v_and_b32_dpp v9, v20, v5 row_newbcast:7 row_mask:0xf bank_mask:0xf
    v_and_b32_dpp v10, v20, v6 row_newbcast:7 row_mask:0xf bank_mask:0xf
    v_and_b32_dpp v11, v20, v7 row_newbcast:7 row_mask:0xf bank_mask:0xf
    s_waitcnt vmcnt(2)
    s_nop 0
    v_mfma_f32_16x16x32_bf16 v[12:15], v[8:11], v[92:95], v[12:15]
    s_mov_b32 s64, 2621440
    buffer_load_dwordx4 v[72:75], v2, s[40:43], s64 offen sc1
    v_and_b32_dpp v8, v20, v4 row_newbcast:8 row_mask:0xf bank_mask:0xf
    v_and_b32_dpp v9, v20, v5 row_newbcast:8 row_mask:0xf bank_mask:0xf
    v_and_b32_dpp v10, v20, v6 row_newbcast:8 row_mask:0xf bank_mask:0xf
    v_and_b32_dpp v11, v20, v7 row_newbcast:8 row_mask:0xf bank_mask:0xf
    s_waitcnt vmcnt(2)
    s_nop 0
    v_mfma_f32_16x16x32_bf16 v[12:15], v[8:11], v[64:67], v[12:15]
    s_mov_b32 s64, 2883584
    buffer_load_dwordx4 v[76:79], v2, s[40:43], s64 offen sc1
    v_and_b32_dpp v8, v20, v4 row_newbcast:9 row_mask:0xf bank_mask:0xf
    v_and_b32_dpp v9, v20, v5 row_newbcast:9 row_mask:0xf bank_mask:0xf
    v_and_b32_dpp v10, v20, v6 row_newbcast:9 row_mask:0xf bank_mask:0xf
    v_and_b32_dpp v11, v20, v7 row_newbcast:9 row_mask:0xf bank_mask:0xf
    s_waitcnt vmcnt(2)
    s_nop 0
    v_mfma_f32_16x16x32_bf16 v[12:15], v[8:11], v[68:71], v[12:15]
    s_mov_b32 s64, 3145728
    buffer_load_dwordx4 v[80:83], v2, s[40:43], s64 offen sc1
    v_and_b32_dpp v8, v20, v4 row_newbcast:10 row_mask:0xf bank_mask:0xf
    v_and_b32_dpp v9, v20, v5 row_newbcast:10 row_mask:0xf bank_mask:0xf
    v_and_b32_dpp v10, v20, v6 row_newbcast:10 row_mask:0xf bank_mask:0xf
    v_and_b32_dpp v11, v20, v7 row_newbcast:10 row_mask:0xf bank_mask:0xf
    s_waitcnt vmcnt(2)
    s_nop 0
    v_mfma_f32_16x16x32_bf16 v[12:15], v[8:11], v[72:75], v[12:15]
    s_mov_b32 s64, 3407872
    buffer_load_dwordx4 v[84:87], v2, s[40:43], s64 offen sc1
    v_and_b32_dpp v8, v20, v4 row_newbcast:11 row_mask:0xf bank_mask:0xf
    v_and_b32_dpp v9, v20, v5 row_newbcast:11 row_mask:0xf bank_mask:0xf
    v_and_b32_dpp v10, v20, v6 row_newbcast:11 row_mask:0xf bank_mask:0xf
    v_and_b32_dpp v11, v20, v7 row_newbcast:11 row_mask:0xf bank_mask:0xf
    s_waitcnt vmcnt(2)
    s_nop 0
    v_mfma_f32_16x16x32_bf16 v[12:15], v[8:11], v[76:79], v[12:15]
    s_mov_b32 s64, 3670016
    buffer_load_dwordx4 v[88:91], v2, s[40:43], s64 offen sc1
    v_and_b32_dpp v8, v20, v4 row_newbcast:12 row_mask:0xf bank_mask:0xf
    v_and_b32_dpp v9, v20, v5 row_newbcast:12 row_mask:0xf bank_mask:0xf
    v_and_b32_dpp v10, v20, v6 row_newbcast:12 row_mask:0xf bank_mask:0xf
    v_and_b32_dpp v11, v20, v7 row_newbcast:12 row_mask:0xf bank_mask:0xf
    s_waitcnt vmcnt(2)
    s_nop 0
    v_mfma_f32_16x16x32_bf16 v[12:15], v[8:11], v[80:83], v[12:15]
    s_mov_b32 s64, 3932160
    buffer_load_dwordx4 v[92:95], v2, s[40:43], s64 offen sc1
    v_and_b32_dpp v8, v20, v4 row_newbcast:13 row_mask:0xf bank_mask:0xf
    v_and_b32_dpp v9, v20, v5 row_newbcast:13 row_mask:0xf bank_mask:0xf
    v_and_b32_dpp v10, v20, v6 row_newbcast:13 row_mask:0xf bank_mask:0xf
    v_and_b32_dpp v11, v20, v7 row_newbcast:13 row_mask:0xf bank_mask:0xf
    s_waitcnt vmcnt(2)
    s_nop 0
    v_mfma_f32_16x16x32_bf16 v[12:15], v[8:11], v[84:87], v[12:15]
    s_mov_b32 s64, 4194304
    buffer_load_dwordx4 v[64:67], v2, s[40:43], s64 offen sc1
    v_and_b32_dpp v8, v20, v4 row_newbcast:14 row_mask:0xf bank_mask:0xf
    v_and_b32_dpp v9, v20, v5 row_newbcast:14 row_mask:0xf bank_mask:0xf
    v_and_b32_dpp v10, v20, v6 row_newbcast:14 row_mask:0xf bank_mask:0xf
    v_and_b32_dpp v11, v20, v7 row_newbcast:14 row_mask:0xf bank_mask:0xf
    s_waitcnt vmcnt(2)
    s_nop 0
    v_mfma_f32_16x16x32_bf16 v[12:15], v[8:11], v[88:91], v[12:15]
    s_mov_b32 s64, 4456448
    buffer_load_dwordx4 v[68:71], v2, s[40:43], s64 offen sc1
    v_and_b32_dpp v8, v20, v4 row_newbcast:15 row_mask:0xf bank_mask:0xf
    v_and_b32_dpp v9, v20, v5 row_newbcast:15 row_mask:0xf bank_mask:0xf
    v_and_b32_dpp v10, v20, v6 row_newbcast:15 row_mask:0xf bank_mask:0xf
    v_and_b32_dpp v11, v20, v7 row_newbcast:15 row_mask:0xf bank_mask:0xf
    s_waitcnt vmcnt(2)
    s_nop 0
    v_mfma_f32_16x16x32_bf16 v[12:15], v[8:11], v[92:95], v[12:15]
    s_mov_b32 s64, 4718592
    buffer_load_dwordx4 v[72:75], v2, s[40:43], s64 offen sc1
    v_and_b32_dpp v8, v21, v4 row_newbcast:0 row_mask:0xf bank_mask:0xf
    v_and_b32_dpp v9, v21, v5 row_newbcast:0 row_mask:0xf bank_mask:0xf
    v_and_b32_dpp v10, v21, v6 row_newbcast:0 row_mask:0xf bank_mask:0xf
    v_and_b32_dpp v11, v21, v7 row_newbcast:0 row_mask:0xf bank_mask:0xf
    s_waitcnt vmcnt(2)
    s_nop 0
    v_mfma_f32_16x16x32_bf16 v[12:15], v[8:11], v[64:67], v[12:15]
    s_mov_b32 s64, 4980736
    buffer_load_dwordx4 v[76:79], v2, s[40:43], s64 offen sc1
    s_barrier
    v_and_b32_dpp v8, v21, v4 row_newbcast:1 row_mask:0xf bank_mask:0xf
    v_and_b32_dpp v9, v21, v5 row_newbcast:1 row_mask:0xf bank_mask:0xf
    v_and_b32_dpp v10, v21, v6 row_newbcast:1 row_mask:0xf bank_mask:0xf
    v_and_b32_dpp v11, v21, v7 row_newbcast:1 row_mask:0xf bank_mask:0xf
    s_waitcnt vmcnt(2)
    s_nop 0
    v_mfma_f32_16x16x32_bf16 v[12:15], v[8:11], v[68:71], v[12:15]
    v_and_b32_dpp v8, v21, v4 row_newbcast:2 row_mask:0xf bank_mask:0xf
    v_and_b32_dpp v9, v21, v5 row_newbcast:2 row_mask:0xf bank_mask:0xf
    v_and_b32_dpp v10, v21, v6 row_newbcast:2 row_mask:0xf bank_mask:0xf
    v_and_b32_dpp v11, v21, v7 row_newbcast:2 row_mask:0xf bank_mask:0xf
    s_waitcnt vmcnt(1)
    s_nop 0
    v_mfma_f32_16x16x32_bf16 v[12:15], v[8:11], v[72:75], v[12:15]
    v_and_b32_dpp v8, v21, v4 row_newbcast:3 row_mask:0xf bank_mask:0xf
    v_and_b32_dpp v9, v21, v5 row_newbcast:3 row_mask:0xf bank_mask:0xf
    v_and_b32_dpp v10, v21, v6 row_newbcast:3 row_mask:0xf bank_mask:0xf
    v_and_b32_dpp v11, v21, v7 row_newbcast:3 row_mask:0xf bank_mask:0xf
    s_waitcnt vmcnt(0)
    s_nop 0
    v_mfma_f32_16x16x32_bf16 v[12:15], v[8:11], v[76:79], v[12:15]
    s_setpc_b64 s[6:7]
L_bo:
    s_cmp_lt_u32 s30, 2
    s_cbranch_scc1 L_bo2
    s_mov_b32 s64, 0
    buffer_load_dwordx4 v[128:131], v3, s[44:47], s64 offen offset:0 sc1
    s_waitcnt vmcnt(2)
    s_mov_b32 s64, 10240
    buffer_load_dwordx4 v[132:135], v3, s[44:47], s64 offen offset:0 sc1
    s_waitcnt vmcnt(2)
    s_mov_b32 s64, 20480
    buffer_load_dwordx4 v[136:139], v3, s[44:47], s64 offen offset:0 sc1
    s_waitcnt vmcnt(2)
    v_mov_b32 v22, v130
    v_mov_b32 v23, v131
    v_mov_b32_dpp v130, v128 row_ror:8 row_mask:0xf bank_mask:0x3
    v_mov_b32_dpp v131, v129 row_ror:8 row_mask:0xf bank_mask:0x3
    v_mov_b32_dpp v128, v22 row_ror:8 row_mask:0xf bank_mask:0xc
    v_mov_b32_dpp v129, v23 row_ror:8 row_mask:0xf bank_mask:0xc
    s_mov_b32 s64, 30720
    buffer_load_dwordx4 v[140:143], v3, s[44:47], s64 offen offset:0 sc1
    s_waitcnt vmcnt(2)
    v_mov_b32 v22, v134
    v_mov_b32 v23, v135
    v_mov_b32_dpp v134, v132 row_ror:8 row_mask:0xf bank_mask:0x3
    v_mov_b32_dpp v135, v133 row_ror:8 row_mask:0xf bank_mask:0x3
    v_mov_b32_dpp v132, v22 row_ror:8 row_mask:0xf bank_mask:0xc
    v_mov_b32_dpp v133, v23 row_ror:8 row_mask:0xf bank_mask:0xc
    s_mov_b32 s64, 40960
    buffer_load_dwordx4 v[144:147], v3, s[44:47], s64 offen offset:0 sc1
    s_waitcnt vmcnt(2)
    v_mov_b32 v22, v138
    v_mov_b32 v23, v139
    v_mov_b32_dpp v138, v136 row_ror:8 row_mask:0xf bank_mask:0x3
    v_mov_b32_dpp v139, v137 row_ror:8 row_mask:0xf bank_mask:0x3
    v_mov_b32_dpp v136, v22 row_ror:8 row_mask:0xf bank_mask:0xc
    v_mov_b32_dpp v137, v23 row_ror:8 row_mask:0xf bank_mask:0xc
    s_mov_b32 s64, 51200
    buffer_load_dwordx4 v[148:151], v3, s[44:47], s64 offen offset:0 sc1
    s_waitcnt vmcnt(2)
    v_mov_b32 v22, v142
    v_mov_b32 v23, v143
    v_mov_b32_dpp v142, v140 row_ror:8 row_mask:0xf bank_mask:0x3
    v_mov_b32_dpp v143, v141 row_ror:8 row_mask:0xf bank_mask:0x3
    v_mov_b32_dpp v140, v22 row_ror:8 row_mask:0xf bank_mask:0xc
    v_mov_b32_dpp v141, v23 row_ror:8 row_mask:0xf bank_mask:0xc
    s_mov_b32 s64, 61440
    buffer_load_dwordx4 v[152:155], v3, s[44:47], s64 offen offset:0 sc1
    s_waitcnt vmcnt(2)
    v_mov_b32 v22, v146
    v_mov_b32 v23, v147
    v_mov_b32_dpp v146, v144 row_ror:8 row_mask:0xf bank_mask:0x3
    v_mov_b32_dpp v147, v145 row_ror:8 row_mask:0xf bank_mask:0x3
    v_mov_b32_dpp v144, v22 row_ror:8 row_mask:0xf bank_mask:0xc
    v_mov_b32_dpp v145, v23 row_ror:8 row_mask:0xf bank_mask:0xc
    s_mov_b32 s64, 71680
    buffer_load_dwordx4 v[156:159], v3, s[44:47], s64 offen offset:0 sc1
    s_waitcnt vmcnt(2)
    v_mov_b32 v22, v150
    v_mov_b32 v23, v151
    v_mov_b32_dpp v150, v148 row_ror:8 row_mask:0xf bank_mask:0x3
    v_mov_b32_dpp v151, v149 row_ror:8 row_mask:0xf bank_mask:0x3
    v_mov_b32_dpp v148, v22 row_ror:8 row_mask:0xf bank_mask:0xc
    v_mov_b32_dpp v149, v23 row_ror:8 row_mask:0xf bank_mask:0xc
    s_mov_b32 s64, 81920
    buffer_load_dwordx4 v[160:163], v3, s[44:47], s64 offen offset:0 sc1
    s_waitcnt vmcnt(2)
    v_mov_b32 v22, v154
    v_mov_b32 v23, v155
    v_mov_b32_dpp v154, v152 row_ror:8 row_mask:0xf bank_mask:0x3
    v_mov_b32_dpp v155, v153 row_ror:8 row_mask:0xf bank_mask:0x3
    v_mov_b32_dpp v152, v22 row_ror:8 row_mask:0xf bank_mask:0xc
    v_mov_b32_dpp v153, v23 row_ror:8 row_mask:0xf bank_mask:0xc
    s_mov_b32 s64, 92160
    buffer_load_dwordx4 v[164:167], v3, s[44:47], s64 offen offset:0 sc1
    s_waitcnt vmcnt(2)
    v_mov_b32 v22, v158
    v_mov_b32 v23, v159
    v_mov_b32_dpp v158, v156 row_ror:8 row_mask:0xf bank_mask:0x3
    v_mov_b32_dpp v159, v157 row_ror:8 row_mask:0xf bank_mask:0x3
    v_mov_b32_dpp v156, v22 row_ror:8 row_mask:0xf bank_mask:0xc
    v_mov_b32_dpp v157, v23 row_ror:8 row_mask:0xf bank_mask:0xc
    s_mov_b32 s64, 102400
    buffer_load_dwordx4 v[168:171], v3, s[44:47], s64 offen offset:0 sc1
    s_waitcnt vmcnt(2)
    v_mov_b32 v22, v162
    v_mov_b32 v23, v163
    v_mov_b32_dpp v162, v160 row_ror:8 row_mask:0xf bank_mask:0x3
    v_mov_b32_dpp v163, v161 row_ror:8 row_mask:0xf bank_mask:0x3
    v_mov_b32_dpp v160, v22 row_ror:8 row_mask:0xf bank_mask:0xc
    v_mov_b32_dpp v161, v23 row_ror:8 row_mask:0xf bank_mask:0xc
    s_mov_b32 s64, 112640
    buffer_load_dwordx4 v[172:175], v3, s[44:47], s64 offen offset:0 sc1
    s_waitcnt vmcnt(2)
    v_mov_b32 v22, v166
    v_mov_b32 v23, v167
    v_mov_b32_dpp v166, v164 row_ror:8 row_mask:0xf bank_mask:0x3
    v_mov_b32_dpp v167, v165 row_ror:8 row_mask:0xf bank_mask:0x3
    v_mov_b32_dpp v164, v22 row_ror:8 row_mask:0xf bank_mask:0xc
    v_mov_b32_dpp v165, v23 row_ror:8 row_mask:0xf bank_mask:0xc
    s_mov_b32 s64, 122880
    buffer_load_dwordx4 v[176:179], v3, s[44:47], s64 offen offset:0 sc1
    s_waitcnt vmcnt(2)
    v_mov_b32 v22, v170
    v_mov_b32 v23, v171
    v_mov_b32_dpp v170, v168 row_ror:8 row_mask:0xf bank_mask:0x3
    v_mov_b32_dpp v171, v169 row_ror:8 row_mask:0xf bank_mask:0x3
    v_mov_b32_dpp v168, v22 row_ror:8 row_mask:0xf bank_mask:0xc
    v_mov_b32_dpp v169, v23 row_ror:8 row_mask:0xf bank_mask:0xc
    s_mov_b32 s64, 133120
    buffer_load_dwordx4 v[180:183], v3, s[44:47], s64 offen offset:0 sc1
    s_waitcnt vmcnt(2)
    v_mov_b32 v22, v174
    v_mov_b32 v23, v175
    v_mov_b32_dpp v174, v172 row_ror:8 row_mask:0xf bank_mask:0x3
    v_mov_b32_dpp v175, v173 row_ror:8 row_mask:0xf bank_mask:0x3
    v_mov_b32_dpp v172, v22 row_ror:8 row_mask:0xf bank_mask:0xc
    v_mov_b32_dpp v173, v23 row_ror:8 row_mask:0xf bank_mask:0xc
    s_mov_b32 s64, 143360
    buffer_load_dwordx4 v[184:187], v3, s[44:47], s64 offen offset:0 sc1
    s_waitcnt vmcnt(2)
    v_mov_b32 v22, v178
    v_mov_b32 v23, v179
    v_mov_b32_dpp v178, v176 row_ror:8 row_mask:0xf bank_mask:0x3
    v_mov_b32_dpp v179, v177 row_ror:8 row_mask:0xf bank_mask:0x3
    v_mov_b32_dpp v176, v22 row_ror:8 row_mask:0xf bank_mask:0xc
    v_mov_b32_dpp v177, v23 row_ror:8 row_mask:0xf bank_mask:0xc
    s_mov_b32 s64, 153600
    buffer_load_dwordx4 v[188:191], v3, s[44:47], s64 offen offset:0 sc1
    s_barrier
    s_setpc_b64 s[6:7]
L_bo2:
    s_mov_b32 s64, 0
    buffer_load_dwordx4 v[128:131], v3, s[44:47], s64 offen offset:0 sc1
    buffer_load_dwordx4 v[192:195], v3, s[44:47], s64 offen offset:1024 sc1
    s_waitcnt vmcnt(4)
    s_mov_b32 s64, 10240
    buffer_load_dwordx4 v[132:135], v3, s[44:47], s64 offen offset:0 sc1
    buffer_load_dwordx4 v[196:199], v3, s[44:47], s64 offen offset:1024 sc1
    s_waitcnt vmcnt(4)
    s_mov_b32 s64, 20480
    buffer_load_dwordx4 v[136:139], v3, s[44:47], s64 offen offset:0 sc1
    buffer_load_dwordx4 v[200:203], v3, s[44:47], s64 offen offset:1024 sc1
    s_waitcnt vmcnt(4)
    v_mov_b32 v22, v130
    v_mov_b32 v23, v131
    v_mov_b32_dpp v130, v128 row_ror:8 row_mask:0xf bank_mask:0x3
    v_mov_b32_dpp v131, v129 row_ror:8 row_mask:0xf bank_mask:0x3
    v_mov_b32_dpp v128, v22 row_ror:8 row_mask:0xf bank_mask:0xc
    v_mov_b32_dpp v129, v23 row_ror:8 row_mask:0xf bank_mask:0xc
    v_mov_b32 v22, v194
    v_mov_b32 v23, v195
    v_mov_b32_dpp v194, v192 row_ror:8 row_mask:0xf bank_mask:0x3
    v_mov_b32_dpp v195, v193 row_ror:8 row_mask:0xf bank_mask:0x3
    v_mov_b32_dpp v192, v22 row_ror:8 row_mask:0xf bank_mask:0xc
    v_mov_b32_dpp v193, v23 row_ror:8 row_mask:0xf bank_mask:0xc
    s_mov_b32 s64, 30720
    buffer_load_dwordx4 v[140:143], v3, s[44:47], s64 offen offset:0 sc1
    buffer_load_dwordx4 v[204:207], v3, s[44:47], s64 offen offset:1024 sc1
    s_waitcnt vmcnt(4)
    v_mov_b32 v22, v134
    v_mov_b32 v23, v135
    v_mov_b32_dpp v134, v132 row_ror:8 row_mask:0xf bank_mask:0x3
    v_mov_b32_dpp v135, v133 row_ror:8 row_mask:0xf bank_mask:0x3
    v_mov_b32_dpp v132, v22 row_ror:8 row_mask:0xf bank_mask:0xc
    v_mov_b32_dpp v133, v23 row_ror:8 row_mask:0xf bank_mask:0xc
    v_mov_b32 v22, v198
    v_mov_b32 v23, v199
    v_mov_b32_dpp v198, v196 row_ror:8 row_mask:0xf bank_mask:0x3
    v_mov_b32_dpp v199, v197 row_ror:8 row_mask:0xf bank_mask:0x3
    v_mov_b32_dpp v196, v22 row_ror:8 row_mask:0xf bank_mask:0xc
    v_mov_b32_dpp v197, v23 row_ror:8 row_mask:0xf bank_mask:0xc
    s_mov_b32 s64, 40960
    buffer_load_dwordx4 v[144:147], v3, s[44:47], s64 offen offset:0 sc1
    buffer_load_dwordx4 v[208:211], v3, s[44:47], s64 offen offset:1024 sc1
    s_waitcnt vmcnt(4)
    v_mov_b32 v22, v138
    v_mov_b32 v23, v139
    v_mov_b32_dpp v138, v136 row_ror:8 row_mask:0xf bank_mask:0x3
    v_mov_b32_dpp v139, v137 row_ror:8 row_mask:0xf bank_mask:0x3
    v_mov_b32_dpp v136, v22 row_ror:8 row_mask:0xf bank_mask:0xc
    v_mov_b32_dpp v137, v23 row_ror:8 row_mask:0xf bank_mask:0xc
    v_mov_b32 v22, v202
    v_mov_b32 v23, v203
    v_mov_b32_dpp v202, v200 row_ror:8 row_mask:0xf bank_mask:0x3
    v_mov_b32_dpp v203, v201 row_ror:8 row_mask:0xf bank_mask:0x3
    v_mov_b32_dpp v200, v22 row_ror:8 row_mask:0xf bank_mask:0xc
    v_mov_b32_dpp v201, v23 row_ror:8 row_mask:0xf bank_mask:0xc
    s_mov_b32 s64, 51200
    buffer_load_dwordx4 v[148:151], v3, s[44:47], s64 offen offset:0 sc1
    buffer_load_dwordx4 v[212:215], v3, s[44:47], s64 offen offset:1024 sc1
    s_waitcnt vmcnt(4)
    v_mov_b32 v22, v142
    v_mov_b32 v23, v143
    v_mov_b32_dpp v142, v140 row_ror:8 row_mask:0xf bank_mask:0x3
    v_mov_b32_dpp v143, v141 row_ror:8 row_mask:0xf bank_mask:0x3
    v_mov_b32_dpp v140, v22 row_ror:8 row_mask:0xf bank_mask:0xc
    v_mov_b32_dpp v141, v23 row_ror:8 row_mask:0xf bank_mask:0xc
    v_mov_b32 v22, v206
    v_mov_b32 v23, v207
    v_mov_b32_dpp v206, v204 row_ror:8 row_mask:0xf bank_mask:0x3
    v_mov_b32_dpp v207, v205 row_ror:8 row_mask:0xf bank_mask:0x3
    v_mov_b32_dpp v204, v22 row_ror:8 row_mask:0xf bank_mask:0xc
    v_mov_b32_dpp v205, v23 row_ror:8 row_mask:0xf bank_mask:0xc
    s_mov_b32 s64, 61440
    buffer_load_dwordx4 v[152:155], v3, s[44:47], s64 offen offset:0 sc1
    buffer_load_dwordx4 v[216:219], v3, s[44:47], s64 offen offset:1024 sc1
    s_waitcnt vmcnt(4)
    v_mov_b32 v22, v146
    v_mov_b32 v23, v147
    v_mov_b32_dpp v146, v144 row_ror:8 row_mask:0xf bank_mask:0x3
    v_mov_b32_dpp v147, v145 row_ror:8 row_mask:0xf bank_mask:0x3
    v_mov_b32_dpp v144, v22 row_ror:8 row_mask:0xf bank_mask:0xc
    v_mov_b32_dpp v145, v23 row_ror:8 row_mask:0xf bank_mask:0xc
    v_mov_b32 v22, v210
    v_mov_b32 v23, v211
    v_mov_b32_dpp v210, v208 row_ror:8 row_mask:0xf bank_mask:0x3
    v_mov_b32_dpp v211, v209 row_ror:8 row_mask:0xf bank_mask:0x3
    v_mov_b32_dpp v208, v22 row_ror:8 row_mask:0xf bank_mask:0xc
    v_mov_b32_dpp v209, v23 row_ror:8 row_mask:0xf bank_mask:0xc
    s_mov_b32 s64, 71680
    buffer_load_dwordx4 v[156:159], v3, s[44:47], s64 offen offset:0 sc1
    buffer_load_dwordx4 v[220:223], v3, s[44:47], s64 offen offset:1024 sc1
    s_waitcnt vmcnt(4)
    v_mov_b32 v22, v150
    v_mov_b32 v23, v151
    v_mov_b32_dpp v150, v148 row_ror:8 row_mask:0xf bank_mask:0x3
    v_mov_b32_dpp v151, v149 row_ror:8 row_mask:0xf bank_mask:0x3
    v_mov_b32_dpp v148, v22 row_ror:8 row_mask:0xf bank_mask:0xc
    v_mov_b32_dpp v149, v23 row_ror:8 row_mask:0xf bank_mask:0xc
    v_mov_b32 v22, v214
    v_mov_b32 v23, v215
    v_mov_b32_dpp v214, v212 row_ror:8 row_mask:0xf bank_mask:0x3
    v_mov_b32_dpp v215, v213 row_ror:8 row_mask:0xf bank_mask:0x3
    v_mov_b32_dpp v212, v22 row_ror:8 row_mask:0xf bank_mask:0xc
    v_mov_b32_dpp v213, v23 row_ror:8 row_mask:0xf bank_mask:0xc
    s_mov_b32 s64, 81920
    buffer_load_dwordx4 v[160:163], v3, s[44:47], s64 offen offset:0 sc1
    buffer_load_dwordx4 v[224:227], v3, s[44:47], s64 offen offset:1024 sc1
    s_waitcnt vmcnt(4)
    v_mov_b32 v22, v154
    v_mov_b32 v23, v155
    v_mov_b32_dpp v154, v152 row_ror:8 row_mask:0xf bank_mask:0x3
    v_mov_b32_dpp v155, v153 row_ror:8 row_mask:0xf bank_mask:0x3
    v_mov_b32_dpp v152, v22 row_ror:8 row_mask:0xf bank_mask:0xc
    v_mov_b32_dpp v153, v23 row_ror:8 row_mask:0xf bank_mask:0xc
    v_mov_b32 v22, v218
    v_mov_b32 v23, v219
    v_mov_b32_dpp v218, v216 row_ror:8 row_mask:0xf bank_mask:0x3
    v_mov_b32_dpp v219, v217 row_ror:8 row_mask:0xf bank_mask:0x3
    v_mov_b32_dpp v216, v22 row_ror:8 row_mask:0xf bank_mask:0xc
    v_mov_b32_dpp v217, v23 row_ror:8 row_mask:0xf bank_mask:0xc
    s_mov_b32 s64, 92160
    buffer_load_dwordx4 v[164:167], v3, s[44:47], s64 offen offset:0 sc1
    buffer_load_dwordx4 v[228:231], v3, s[44:47], s64 offen offset:1024 sc1
    s_waitcnt vmcnt(4)
    v_mov_b32 v22, v158
    v_mov_b32 v23, v159
    v_mov_b32_dpp v158, v156 row_ror:8 row_mask:0xf bank_mask:0x3
    v_mov_b32_dpp v159, v157 row_ror:8 row_mask:0xf bank_mask:0x3
    v_mov_b32_dpp v156, v22 row_ror:8 row_mask:0xf bank_mask:0xc
    v_mov_b32_dpp v157, v23 row_ror:8 row_mask:0xf bank_mask:0xc
    v_mov_b32 v22, v222
    v_mov_b32 v23, v223
    v_mov_b32_dpp v222, v220 row_ror:8 row_mask:0xf bank_mask:0x3
    v_mov_b32_dpp v223, v221 row_ror:8 row_mask:0xf bank_mask:0x3
    v_mov_b32_dpp v220, v22 row_ror:8 row_mask:0xf bank_mask:0xc
    v_mov_b32_dpp v221, v23 row_ror:8 row_mask:0xf bank_mask:0xc
    s_mov_b32 s64, 102400
    buffer_load_dwordx4 v[168:171], v3, s[44:47], s64 offen offset:0 sc1
    buffer_load_dwordx4 v[232:235], v3, s[44:47], s64 offen offset:1024 sc1
    s_waitcnt vmcnt(4)
    v_mov_b32 v22, v162
    v_mov_b32 v23, v163
    v_mov_b32_dpp v162, v160 row_ror:8 row_mask:0xf bank_mask:0x3
    v_mov_b32_dpp v163, v161 row_ror:8 row_mask:0xf bank_mask:0x3
    v_mov_b32_dpp v160, v22 row_ror:8 row_mask:0xf bank_mask:0xc
    v_mov_b32_dpp v161, v23 row_ror:8 row_mask:0xf bank_mask:0xc
    v_mov_b32 v22, v226
    v_mov_b32 v23, v227
    v_mov_b32_dpp v226, v224 row_ror:8 row_mask:0xf bank_mask:0x3
    v_mov_b32_dpp v227, v225 row_ror:8 row_mask:0xf bank_mask:0x3
    v_mov_b32_dpp v224, v22 row_ror:8 row_mask:0xf bank_mask:0xc
    v_mov_b32_dpp v225, v23 row_ror:8 row_mask:0xf bank_mask:0xc
    s_mov_b32 s64, 112640
    buffer_load_dwordx4 v[172:175], v3, s[44:47], s64 offen offset:0 sc1
    buffer_load_dwordx4 v[236:239], v3, s[44:47], s64 offen offset:1024 sc1
    s_waitcnt vmcnt(4)
    v_mov_b32 v22, v166
    v_mov_b32 v23, v167
    v_mov_b32_dpp v166, v164 row_ror:8 row_mask:0xf bank_mask:0x3
    v_mov_b32_dpp v167, v165 row_ror:8 row_mask:0xf bank_mask:0x3
    v_mov_b32_dpp v164, v22 row_ror:8 row_mask:0xf bank_mask:0xc
    v_mov_b32_dpp v165, v23 row_ror:8 row_mask:0xf bank_mask:0xc
    v_mov_b32 v22, v230
    v_mov_b32 v23, v231
    v_mov_b32_dpp v230, v228 row_ror:8 row_mask:0xf bank_mask:0x3
    v_mov_b32_dpp v231, v229 row_ror:8 row_mask:0xf bank_mask:0x3
    v_mov_b32_dpp v228, v22 row_ror:8 row_mask:0xf bank_mask:0xc
    v_mov_b32_dpp v229, v23 row_ror:8 row_mask:0xf bank_mask:0xc
    s_mov_b32 s64, 122880
    buffer_load_dwordx4 v[176:179], v3, s[44:47], s64 offen offset:0 sc1
    buffer_load_dwordx4 v[240:243], v3, s[44:47], s64 offen offset:1024 sc1
    s_waitcnt vmcnt(4)
    v_mov_b32 v22, v170
    v_mov_b32 v23, v171
    v_mov_b32_dpp v170, v168 row_ror:8 row_mask:0xf bank_mask:0x3
    v_mov_b32_dpp v171, v169 row_ror:8 row_mask:0xf bank_mask:0x3
    v_mov_b32_dpp v168, v22 row_ror:8 row_mask:0xf bank_mask:0xc
    v_mov_b32_dpp v169, v23 row_ror:8 row_mask:0xf bank_mask:0xc
    v_mov_b32 v22, v234
    v_mov_b32 v23, v235
    v_mov_b32_dpp v234, v232 row_ror:8 row_mask:0xf bank_mask:0x3
    v_mov_b32_dpp v235, v233 row_ror:8 row_mask:0xf bank_mask:0x3
    v_mov_b32_dpp v232, v22 row_ror:8 row_mask:0xf bank_mask:0xc
    v_mov_b32_dpp v233, v23 row_ror:8 row_mask:0xf bank_mask:0xc
    s_mov_b32 s64, 133120
    buffer_load_dwordx4 v[180:183], v3, s[44:47], s64 offen offset:0 sc1
    buffer_load_dwordx4 v[244:247], v3, s[44:47], s64 offen offset:1024 sc1
    s_waitcnt vmcnt(4)
    v_mov_b32 v22, v174
    v_mov_b32 v23, v175
    v_mov_b32_dpp v174, v172 row_ror:8 row_mask:0xf bank_mask:0x3
    v_mov_b32_dpp v175, v173 row_ror:8 row_mask:0xf bank_mask:0x3
    v_mov_b32_dpp v172, v22 row_ror:8 row_mask:0xf bank_mask:0xc
    v_mov_b32_dpp v173, v23 row_ror:8 row_mask:0xf bank_mask:0xc
    v_mov_b32 v22, v238
    v_mov_b32 v23, v239
    v_mov_b32_dpp v238, v236 row_ror:8 row_mask:0xf bank_mask:0x3
    v_mov_b32_dpp v239, v237 row_ror:8 row_mask:0xf bank_mask:0x3
    v_mov_b32_dpp v236, v22 row_ror:8 row_mask:0xf bank_mask:0xc
    v_mov_b32_dpp v237, v23 row_ror:8 row_mask:0xf bank_mask:0xc
    s_mov_b32 s64, 143360
    buffer_load_dwordx4 v[184:187], v3, s[44:47], s64 offen offset:0 sc1
    buffer_load_dwordx4 v[248:251], v3, s[44:47], s64 offen offset:1024 sc1
    s_waitcnt vmcnt(4)
    v_mov_b32 v22, v178
    v_mov_b32 v23, v179
    v_mov_b32_dpp v178, v176 row_ror:8 row_mask:0xf bank_mask:0x3
    v_mov_b32_dpp v179, v177 row_ror:8 row_mask:0xf bank_mask:0x3
    v_mov_b32_dpp v176, v22 row_ror:8 row_mask:0xf bank_mask:0xc
    v_mov_b32_dpp v177, v23 row_ror:8 row_mask:0xf bank_mask:0xc
    v_mov_b32 v22, v242
    v_mov_b32 v23, v243
    v_mov_b32_dpp v242, v240 row_ror:8 row_mask:0xf bank_mask:0x3
    v_mov_b32_dpp v243, v241 row_ror:8 row_mask:0xf bank_mask:0x3
    v_mov_b32_dpp v240, v22 row_ror:8 row_mask:0xf bank_mask:0xc
    v_mov_b32_dpp v241, v23 row_ror:8 row_mask:0xf bank_mask:0xc
    s_mov_b32 s64, 153600
    buffer_load_dwordx4 v[188:191], v3, s[44:47], s64 offen offset:0 sc1
    buffer_load_dwordx4 v[252:255], v3, s[44:47], s64 offen offset:1024 sc1
    s_barrier
    s_setpc_b64 s[6:7]
L_code_end:
.section .rodata,"a"
.p2align 6
.amdhsa_kernel sequential_preLN__sliding_block_cached__moe_arch_mod__decode_kernel
  .amdhsa_next_free_vgpr 256
  .amdhsa_next_free_sgpr 102
  .amdhsa_accum_offset 256
  .amdhsa_group_segment_fixed_size 0
  .amdhsa_kernarg_size 104
  .amdhsa_user_sgpr_count 2
  .amdhsa_user_sgpr_kernarg_segment_ptr 1
  .amdhsa_system_sgpr_workgroup_id_x 1
  .amdhsa_float_denorm_mode_32 3
.end_amdhsa_kernel
```
